```python
import torch

def _softmax(x, axis=-1):
    return torch.softmax(x, dim=axis)
def _gelu(x):
    return torch.nn.functional.gelu(x, approximate="tanh")
def _silu(x):
    return torch.nn.functional.silu(x)
def _sigmoid(x):
    return torch.sigmoid(x)
def _layernorm(x, axis=-1, eps=1e-5):
    m = x.mean(dim=axis, keepdim=True)
    v = x.var(dim=axis, keepdim=True, unbiased=False)
    return (x - m) / torch.sqrt(v + eps)
def _scatter_add(tgt, idx, src, axis=0):
    return tgt.clone().index_add_(axis, idx, src)
def _segment_sum(src, seg, n):
    out = torch.zeros((n,) + src.shape[1:], dtype=src.dtype)
    return out.index_add_(0, seg, src)
def _pad(x, pw):
    flat = tuple(v for pair in reversed(pw) for v in pair)
    return torch.nn.functional.pad(x, flat)

kernel_name = 'standalone__weight_only_int_quip__sampling'

def setup_inputs():

    _w = (lambda a: (lambda t: t.to(torch.bfloat16) if t.is_floating_point() else t)(torch.as_tensor(a)))
    B, S, D, F = 16, 4, 1024, 3584
    G = 32 if 32 > 0 else D
    D = (D // G) * G
    ng = D // G
    bits = 3 if 3 > 0 else 4
    qmax = 1 << bits
    qw = torch.randint(0, qmax, (D, F)).to(torch.int32)
    U, _ = (lambda *_a, **_k: torch.linalg.qr(*[torch.as_tensor(_x).float() for _x in _a], **_k))((lambda *s: torch.randn(*s, dtype=torch.bfloat16) * 0.05)(D, D))
    V, _ = (lambda *_a, **_k: torch.linalg.qr(*[torch.as_tensor(_x).float() for _x in _a], **_k))((lambda *s: torch.randn(*s, dtype=torch.bfloat16) * 0.05)(F, F))
    return {
        "x": _w((lambda *s: torch.randn(*s, dtype=torch.bfloat16) * 0.05)(B, S, D)),
        "qw": _w(qw),
        "scales": _w(torch.abs((lambda *s: torch.randn(*s, dtype=torch.bfloat16) * 0.05)(ng, F)) * 0.02 + 0.005),
        "zeros": _w(torch.full((ng, F), qmax / 2.0, dtype=float)),
        "U": _w(U.to(float)),
        "V": _w(V.to(float)),
    }

def reference(x, qw, scales, zeros, U, V):
    B, S, D = x.shape
    ng, F = scales.shape
    G = D // ng
    s = (lambda x, n, axis: torch.repeat_interleave(x, n, dim=axis))(scales, G, axis=0)
    z = (lambda x, n, axis: torch.repeat_interleave(x, n, dim=axis))(zeros, G, axis=0)
    wq = ((lambda x, dt: x.to(dt))(qw, x.dtype) - z) * s
    xr = torch.einsum("bsd,de->bse", x, U)
    h  = torch.einsum("bse,ef->bsf", xr, wq)
    y  = torch.einsum("bsf,fg->bsg", h, V)
    return y
```

```asm
; @launch grid=(256,1,1) block=(512,1,1) lds=163840
.amdgcn_target "amdgcn-amd-amdhsa--gfx950"
.text
.globl standalone__weight_only_int_quip__sampling_kernel
.p2align 8
.type standalone__weight_only_int_quip__sampling_kernel,@function
standalone__weight_only_int_quip__sampling_kernel:
    s_load_dwordx16 s[4:19], s[0:1], 0
    s_load_dwordx2 s[20:21], s[0:1], 64
    v_lshrrev_b32 v4, 6, v0
    v_and_b32 v3, 63, v0
    s_lshr_b32 s23, s2, 3
    v_readfirstlane_b32 s3, v4
    s_and_b32 s22, s2, 7
    v_and_b32 v1, 15, v0
    v_bfe_u32 v2, v0, 4, 2
    s_cmp_lt_u32 s23, 14
    s_cbranch_scc1 L_roleA
    s_cmp_ge_u32 s23, 30
    s_cbranch_scc1 L_help
    s_sub_u32 s28, s23, 14
    s_and_b32 s44, s28, 3
    s_lshr_b32 s29, s28, 2
    s_lshl_b32 s45, s22, 2
    s_add_u32 s45, s45, s29
    s_lshl_b32 s26, s3, 18
    s_lshl_b32 s27, s45, 6
    s_add_u32 s26, s26, s27
    v_and_b32 v4, 2, v2
    v_xor_b32 v4, v4, v3
    v_and_b32 v4, 3, v4
    v_lshrrev_b32 v5, 2, v3
    v_lshlrev_b32 v5, 11, v5
    v_lshl_add_u32 v5, v4, 4, v5
    v_add_u32 v5, s26, v5
    s_lshl_b32 s26, s44, 15
    s_lshl_b32 s27, s3, 8
    s_add_u32 s26, s26, s27
    v_xor_b32 v6, v1, v2
    v_lshlrev_b32 v6, 4, v6
    v_lshl_add_u32 v6, v2, 11, v6
    v_add_u32 v6, s26, v6
    s_mul_i32 s46, s3, 12288
    s_and_b32 s40, s28, 7
    s_mov_b32 s41, s29
    s_waitcnt lgkmcnt(0)
    s_mov_b32 s52, s4
    s_mov_b32 s53, s5
    s_mov_b32 s54, 0x20000
    s_mov_b32 s55, 0x20000
    s_mov_b32 s56, s12
    s_mov_b32 s57, s13
    s_mov_b32 s58, 0x200000
    s_mov_b32 s59, 0x20000
    s_xor_b32 s28, s41, 0
    s_lshl_b32 s29, s28, 6
    v_xor_b32 v7, s29, v6
    s_lshl_b32 s29, s28, 10
    s_add_u32 s29, s29, s46
    s_add_u32 m0, s29, 8192
    s_lshl_b32 s28, s28, 13
    buffer_load_dwordx4 v7, s[52:55], s28 offen lds
    s_xor_b32 s28, s40, 0
    s_lshl_b32 s29, s28, 10
    s_add_u32 m0, s29, s46
    s_lshl_b32 s28, s28, 15
    buffer_load_dwordx4 v5, s[56:59], s28 offen lds
    s_xor_b32 s28, s40, 1
    s_lshl_b32 s29, s28, 10
    s_add_u32 m0, s29, s46
    s_lshl_b32 s28, s28, 15
    buffer_load_dwordx4 v5, s[56:59], s28 offen lds
    s_mov_b32 s64, s20
    s_mov_b32 s65, s21
    s_mov_b32 s66, 0x500000
    s_mov_b32 s67, 0x20000
    v_bfe_u32 v4, v3, 2, 2
    v_lshl_add_u32 v4, v2, 3, v4
    v_lshlrev_b32 v4, 6, v4
    v_and_b32 v12, 3, v3
    v_lshl_add_u32 v4, v12, 3, v4
    v_and_b32 v12, 1, v2
    v_lshl_add_u32 v4, v12, 5, v4
    v_add_u32 v8, s46, v4
    v_xor_b32 v9, 32, v8
    v_xor_b32 v4, v1, v2
    v_lshlrev_b32 v4, 4, v4
    v_lshl_add_u32 v4, v1, 8, v4
    v_add_u32 v12, s46, v4
    v_xor_b32 v13, 64, v12
    v_xor_b32 v14, 128, v12
    v_xor_b32 v15, 192, v12
    s_mov_b32 s68, s14
    s_mov_b32 s69, s15
    s_mov_b32 s70, 0x1880000
    s_mov_b32 s71, 0x20000
    s_add_u32 s39, s22, 3
    s_and_b32 s39, s39, 7
    s_and_b32 s48, s23, 3
    s_lshr_b32 s26, s23, 2
    s_add_u32 s26, s26, s39
    s_cmp_ge_u32 s26, 14
    s_cselect_b32 s27, 14, 0
    s_sub_u32 s26, s26, s27
    s_cmp_ge_u32 s26, 7
    s_cselect_b32 s27, 7, 0
    s_sub_u32 s26, s26, s27
    s_mul_i32 s47, s22, 7
    s_add_u32 s47, s47, s26
    s_lshr_b32 s49, s23, 2
    s_lshr_b32 s27, s3, 2
    s_mul_i32 s76, s27, 28672
    s_mul_i32 s26, s27, 224
    s_and_b32 s27, s3, 3
    s_lshl_b32 s27, s27, 3
    s_add_u32 s26, s26, s27
    s_lshl_b32 s27, s27, 7
    s_add_u32 s76, s76, s27
    s_mul_i32 s27, s48, 896
    s_add_u32 s26, s26, s27
    s_mul_i32 s26, s26, 7168
    s_lshl_b32 s27, s47, 7
    s_add_u32 s26, s26, s27
    v_lshrrev_b32 v250, 2, v3
    v_and_b32 v250, 4, v250
    v_xor_b32 v249, v250, v3
    v_and_b32 v249, 7, v249
    v_lshlrev_b32 v249, 4, v249
    v_lshrrev_b32 v250, 3, v3
    v_mul_u32_u24 v250, 7168, v250
    v_add3_u32 v254, v249, v250, s26
    s_lshr_b32 s26, s3, 1
    s_and_b32 s29, s3, 1
    s_mul_i32 s27, s48, 28
    s_mul_i32 s28, s26, 7
    s_add_u32 s27, s27, s28
    s_lshl_b32 s27, s27, 1
    s_add_u32 s27, s27, s29
    s_lshl_b32 s27, s27, 11
    s_add_u32 s27, s27, 131072
    v_min_u32 v238, 13, v3
    v_and_b32 v239, 1, v238
    v_lshrrev_b32 v238, 1, v238
    v_lshlrev_b32 v238, 12, v238
    v_lshl_add_u32 v238, v239, 10, v238
    v_add_u32 v253, s27, v238
    v_and_b32 v239, 1, v2
    v_lshrrev_b32 v241, 1, v2
    v_lshlrev_b32 v238, 4, v1
    v_lshl_add_u32 v238, v241, 8, v238
    v_lshl_add_u32 v238, v239, 10, v238
    v_add_u32 v255, s27, v238
    s_add_u32 s4, s49, 0
    s_cmp_ge_u32 s4, 7
    s_cselect_b32 s27, 7, 0
    s_sub_u32 s4, s4, s27
    s_lshl_b32 s4, s4, 12
    s_add_u32 s5, s49, 1
    s_cmp_ge_u32 s5, 7
    s_cselect_b32 s27, 7, 0
    s_sub_u32 s5, s5, s27
    s_lshl_b32 s5, s5, 12
    s_add_u32 s8, s49, 2
    s_cmp_ge_u32 s8, 7
    s_cselect_b32 s27, 7, 0
    s_sub_u32 s8, s8, s27
    s_lshl_b32 s8, s8, 12
    s_add_u32 s9, s49, 3
    s_cmp_ge_u32 s9, 7
    s_cselect_b32 s27, 7, 0
    s_sub_u32 s9, s9, s27
    s_lshl_b32 s9, s9, 12
    s_add_u32 s10, s49, 4
    s_cmp_ge_u32 s10, 7
    s_cselect_b32 s27, 7, 0
    s_sub_u32 s10, s10, s27
    s_lshl_b32 s10, s10, 12
    s_add_u32 s11, s49, 5
    s_cmp_ge_u32 s11, 7
    s_cselect_b32 s27, 7, 0
    s_sub_u32 s11, s11, s27
    s_lshl_b32 s11, s11, 12
    s_add_u32 s12, s49, 6
    s_cmp_ge_u32 s12, 7
    s_cselect_b32 s27, 7, 0
    s_sub_u32 s12, s12, s27
    s_lshl_b32 s12, s12, 12
    v_bfe_u32 v246, v3, 2, 2
    v_lshl_add_u32 v241, v241, 3, v246
    v_lshlrev_b32 v241, 7, v241
    v_and_b32 v246, 2, v246
    v_xor_b32 v239, v239, v246
    v_xor_b32 v239, s26, v239
    v_lshl_add_u32 v241, v239, 5, v241
    v_and_b32 v246, 3, v3
    v_lshl_add_u32 v241, v246, 3, v241
    s_mul_i32 s27, s26, 28672
    v_add_u32 v232, s27, v241
    v_xor_b32 v233, 64, v232
    s_mul_i32 s28, s47, 49152
    s_mul_i32 s27, s29, 6144
    s_add_u32 s28, s28, s27
    s_mul_i32 s27, s26, 12288
    s_add_u32 s28, s28, s27
    s_add_u32 s28, s28, 2097152
    v_lshl_add_u32 v252, v3, 4, s28
    s_sub_u32 s72, s48, s26
    s_sub_u32 s72, s72, 1
    s_and_b32 s72, s72, 3
    s_lshl_b32 s72, s72, 11
    s_movk_i32 s74, 4096
    s_xor_b32 s75, s26, s48
    v_mov_b32 v245, 0xffffff00
    v_lshlrev_b32 v239, 4, v3
    s_xor_b32 s27, s3, 0
    s_mul_i32 s27, s27, 6144
    s_add_u32 s27, s27, 114688
    v_add_u32 v234, s27, v239
    s_xor_b32 s27, s3, 2
    s_mul_i32 s27, s27, 6144
    s_add_u32 s27, s27, 114688
    v_add_u32 v235, s27, v239
    s_xor_b32 s27, s3, 4
    s_mul_i32 s27, s27, 6144
    s_add_u32 s27, s27, 116736
    v_add_u32 v236, s27, v239
    s_xor_b32 s27, s3, 6
    s_mul_i32 s27, s27, 6144
    s_add_u32 s27, s27, 118784
    v_add_u32 v237, s27, v239
    s_mul_i32 s28, s29, 229376
    s_lshl_b32 s27, s47, 7
    s_add_u32 s28, s28, s27
    s_lshl_b32 s27, s48, 5
    s_add_u32 s28, s28, s27
    v_and_b32 v241, 31, v3
    v_mul_u32_u24 v241, 7168, v241
    v_lshrrev_b32 v246, 5, v3
    v_lshl_add_u32 v241, v246, 4, v241
    v_add_u32 v251, s28, v241
    s_and_b32 s13, s23, 28
    s_add_u32 s13, s13, s26
    s_lshl_b32 s13, s13, 3
    s_add_u32 s13, s13, s22
    s_lshl_b32 s13, s13, 7
    s_add_u32 s13, s13, 2031616
    s_sub_u32 s77, s23, 14
    s_mul_i32 s77, s77, 6
    s_add_u32 s77, s77, 16
    s_add_u32 s25, s77, 6
    s_sub_u32 s26, s23, 28
    s_mul_i32 s26, s26, 16
    s_add_u32 s26, s26, 124
    s_add_u32 s27, s26, 16
    s_cmp_ge_u32 s23, 28
    s_cselect_b32 s77, s26, s77
    s_cselect_b32 s25, s27, s25
    s_min_u32 s25, s25, 154
    s_sub_u32 s26, 7, s3
    s_add_u32 s77, s77, s26
    s_sub_u32 s29, s23, 14
    s_min_u32 s29, s29, 13
    s_and_b32 s43, s29, 3
    s_lshr_b32 s26, s29, 2
    s_add_u32 s26, s26, s39
    s_cmp_ge_u32 s26, 14
    s_cselect_b32 s27, 14, 0
    s_sub_u32 s26, s26, s27
    s_cmp_ge_u32 s26, 7
    s_cselect_b32 s27, 7, 0
    s_sub_u32 s26, s26, s27
    s_mul_i32 s42, s22, 7
    s_add_u32 s42, s42, s26
    s_lshr_b32 s97, s29, 2
    s_lshr_b32 s27, s3, 2
    s_mul_i32 s26, s27, 224
    s_and_b32 s27, s3, 3
    s_lshl_b32 s27, s27, 3
    s_add_u32 s26, s26, s27
    s_mul_i32 s27, s43, 896
    s_add_u32 s26, s26, s27
    s_mul_i32 s26, s26, 7168
    s_lshl_b32 s27, s42, 7
    s_add_u32 s96, s26, s27
    s_add_u32 s98, s97, 5
    s_cmp_ge_u32 s98, 7
    s_cselect_b32 s27, 7, 0
    s_sub_u32 s98, s98, s27
    s_add_u32 s98, s98, 14
    s_mul_i32 s98, s98, 229376
    s_add_u32 s98, s98, s96
    s_add_u32 s98, s98, s14
    s_addc_u32 s99, s15, 0
    s_load_dwordx2 s[100:101], s[98:99], 60
    s_load_dwordx2 s[100:101], s[98:99], 7228
    s_load_dwordx2 s[100:101], s[98:99], 14396
    s_load_dwordx2 s[100:101], s[98:99], 21564
    s_load_dwordx2 s[100:101], s[98:99], 28732
    s_load_dwordx2 s[100:101], s[98:99], 35900
    s_load_dwordx2 s[100:101], s[98:99], 43068
    s_waitcnt vmcnt(1)
    s_xor_b32 s28, s41, 1
    s_lshl_b32 s29, s28, 6
    v_xor_b32 v7, s29, v6
    s_lshl_b32 s29, s28, 10
    s_add_u32 s29, s29, s46
    s_add_u32 m0, s29, 8192
    s_lshl_b32 s28, s28, 13
    buffer_load_dwordx4 v7, s[52:55], s28 offen lds
    s_xor_b32 s28, s40, 2
    s_lshl_b32 s29, s28, 10
    s_add_u32 m0, s29, s46
    s_lshl_b32 s28, s28, 15
    buffer_load_dwordx4 v5, s[56:59], s28 offen lds
    s_xor_b32 s28, s40, 3
    s_lshl_b32 s29, s28, 10
    s_add_u32 m0, s29, s46
    s_lshl_b32 s28, s28, 15
    buffer_load_dwordx4 v5, s[56:59], s28 offen lds
    s_xor_b32 s28, s41, 2
    s_lshl_b32 s29, s28, 6
    v_xor_b32 v7, s29, v6
    s_lshl_b32 s29, s28, 10
    s_add_u32 s29, s29, s46
    s_add_u32 m0, s29, 8192
    s_lshl_b32 s28, s28, 13
    buffer_load_dwordx4 v7, s[52:55], s28 offen lds
    s_xor_b32 s28, s40, 4
    s_lshl_b32 s29, s28, 10
    s_add_u32 m0, s29, s46
    s_lshl_b32 s28, s28, 15
    buffer_load_dwordx4 v5, s[56:59], s28 offen lds
    s_xor_b32 s28, s40, 5
    s_lshl_b32 s29, s28, 10
    s_add_u32 m0, s29, s46
    s_lshl_b32 s28, s28, 15
    buffer_load_dwordx4 v5, s[56:59], s28 offen lds
    s_xor_b32 s28, s41, 3
    s_lshl_b32 s29, s28, 6
    v_xor_b32 v7, s29, v6
    s_lshl_b32 s29, s28, 10
    s_add_u32 s29, s29, s46
    s_add_u32 m0, s29, 8192
    s_lshl_b32 s28, s28, 13
    buffer_load_dwordx4 v7, s[52:55], s28 offen lds
    s_xor_b32 s28, s40, 6
    s_lshl_b32 s29, s28, 10
    s_add_u32 m0, s29, s46
    s_lshl_b32 s28, s28, 15
    buffer_load_dwordx4 v5, s[56:59], s28 offen lds
    s_xor_b32 s28, s40, 7
    s_lshl_b32 s29, s28, 10
    s_add_u32 m0, s29, s46
    s_lshl_b32 s28, s28, 15
    buffer_load_dwordx4 v5, s[56:59], s28 offen lds
    s_barrier
    s_cmp_lt_u32 s3, 4
    s_cbranch_scc1 L_p1_w0all
    s_sub_u32 s24, s23, 14
    s_cmp_eq_u32 s3, 7
    s_cbranch_scc1 L_p1_q3
    s_sub_u32 s26, 6, s3
    s_lshl_b32 s26, s26, 4
    s_add_u32 s24, s24, s26
    s_mul_i32 s28, s24, 4682
    s_lshr_b32 s28, s28, 16
    s_mul_i32 s29, s28, 14
    s_sub_u32 s29, s24, s29
    s_sub_u32 s28, 15, s28
    s_branch L_p1_qgo
L_p1_q3:
    s_and_b32 s28, s24, 1
    s_lshl_b32 s29, s22, 1
    s_add_u32 s29, s29, 3
    s_and_b32 s29, s29, 7
    s_lshl_b32 s26, s28, 3
    s_add_u32 s29, s29, s26
    s_cmp_ge_u32 s29, 14
    s_cbranch_scc1 L_p1_w0all
    s_lshr_b32 s28, s24, 1
    s_sub_u32 s28, 12, s28
L_p1_qgo:
    s_and_b32 s26, s29, 3
    s_lshl_b32 s26, s26, 2
    s_xor_b32 s28, s28, s26
    s_mul_i32 s26, s28, 114688
    s_mul_i32 s27, s22, 14
    s_add_u32 s27, s27, s29
    s_lshl_b32 s27, s27, 7
    s_add_u32 s26, s26, s27
    s_mov_b32 s60, s6
    s_mov_b32 s61, s7
    s_mov_b32 s62, 0xe00000
    s_mov_b32 s63, 0x20000
    v_lshrrev_b32 v244, 3, v3
    v_and_b32 v249, 7, v3
    v_lshl_add_u32 v244, v244, 7, v249
    v_mul_u32_u24 v244, 14336, v244
    buffer_load_dword v248, v244, s[60:63], s26 offen
    s_branch L_p1_w1
L_p1_w0all:
    s_waitcnt vmcnt(0)
L_p1_w1:
    s_waitcnt vmcnt(1) lgkmcnt(0)
    ds_read_b128 v[16:19], v12 offset:8192
    ds_read_b64_tr_b16 v[32:33], v8 offset:0
    ds_read_b64_tr_b16 v[34:35], v8 offset:256
    ds_read_b64_tr_b16 v[36:37], v9 offset:0
    ds_read_b64_tr_b16 v[38:39], v9 offset:256
    ds_read_b128 v[20:23], v13 offset:8192
    ds_read_b64_tr_b16 v[40:41], v8 offset:2048
    ds_read_b64_tr_b16 v[42:43], v8 offset:2304
    ds_read_b64_tr_b16 v[44:45], v9 offset:2048
    ds_read_b64_tr_b16 v[46:47], v9 offset:2304
    ds_read_b128 v[24:27], v14 offset:8192
    ds_read_b64_tr_b16 v[48:49], v8 offset:4096
    ds_read_b64_tr_b16 v[50:51], v8 offset:4352
    ds_read_b64_tr_b16 v[52:53], v9 offset:4096
    ds_read_b64_tr_b16 v[54:55], v9 offset:4352
    ds_read_b128 v[28:31], v15 offset:8192
    ds_read_b64_tr_b16 v[56:57], v8 offset:6144
    ds_read_b64_tr_b16 v[58:59], v8 offset:6400
    ds_read_b64_tr_b16 v[60:61], v9 offset:6144
    ds_read_b64_tr_b16 v[62:63], v9 offset:6400
    s_lshl_b32 s26, s3, 11
    s_add_u32 s26, s26, 131072
    v_lshl_add_u32 v4, v3, 4, s26
    s_waitcnt lgkmcnt(15)
    v_mfma_f32_16x16x32_bf16 v[96:99], v[32:35], v[16:19], 0
    v_mfma_f32_16x16x32_bf16 v[100:103], v[36:39], v[16:19], 0
    s_waitcnt lgkmcnt(10)
    v_mfma_f32_16x16x32_bf16 v[96:99], v[40:43], v[20:23], v[96:99]
    v_mfma_f32_16x16x32_bf16 v[100:103], v[44:47], v[20:23], v[100:103]
    s_waitcnt lgkmcnt(5)
    v_mfma_f32_16x16x32_bf16 v[96:99], v[48:51], v[24:27], v[96:99]
    v_mfma_f32_16x16x32_bf16 v[100:103], v[52:55], v[24:27], v[100:103]
    s_waitcnt lgkmcnt(0)
    v_mfma_f32_16x16x32_bf16 v[96:99], v[56:59], v[28:31], v[96:99]
    v_mfma_f32_16x16x32_bf16 v[100:103], v[60:63], v[28:31], v[100:103]
    s_cmp_eq_u32 s3, 0
    s_cbranch_scc1 L_p1_w0
    s_nop 6
    ds_write_b128 v4, v[96:99] offset:0
    ds_write_b128 v4, v[100:103] offset:1024
    s_waitcnt lgkmcnt(0)
    s_barrier
    s_branch L_p1_bar2
L_p1_w0:
    s_load_dwordx2 s[36:37], s[18:19], 0
    s_lshl_b32 s28, s45, 2
    s_add_u32 s28, s28, s44
    s_lshl_b32 s28, s28, 10
    v_lshlrev_b32 v5, 4, v3
    s_barrier
    ds_read_b128 v[24:27], v4 offset:2048
    ds_read_b128 v[28:31], v4 offset:3072
    ds_read_b128 v[32:35], v4 offset:4096
    ds_read_b128 v[36:39], v4 offset:5120
    ds_read_b128 v[40:43], v4 offset:6144
    ds_read_b128 v[44:47], v4 offset:7168
    ds_read_b128 v[48:51], v4 offset:8192
    ds_read_b128 v[52:55], v4 offset:9216
    ds_read_b128 v[56:59], v4 offset:10240
    ds_read_b128 v[60:63], v4 offset:11264
    ds_read_b128 v[64:67], v4 offset:12288
    ds_read_b128 v[68:71], v4 offset:13312
    ds_read_b128 v[72:75], v4 offset:14336
    ds_read_b128 v[76:79], v4 offset:15360
    s_waitcnt lgkmcnt(0)
    v_pk_add_f32 v[96:97], v[96:97], v[24:25]
    v_pk_add_f32 v[98:99], v[98:99], v[26:27]
    v_pk_add_f32 v[100:101], v[100:101], v[28:29]
    v_pk_add_f32 v[102:103], v[102:103], v[30:31]
    v_pk_add_f32 v[32:33], v[32:33], v[40:41]
    v_pk_add_f32 v[34:35], v[34:35], v[42:43]
    v_pk_add_f32 v[36:37], v[36:37], v[44:45]
    v_pk_add_f32 v[38:39], v[38:39], v[46:47]
    v_pk_add_f32 v[48:49], v[48:49], v[56:57]
    v_pk_add_f32 v[50:51], v[50:51], v[58:59]
    v_pk_add_f32 v[52:53], v[52:53], v[60:61]
    v_pk_add_f32 v[54:55], v[54:55], v[62:63]
    v_pk_add_f32 v[64:65], v[64:65], v[72:73]
    v_pk_add_f32 v[66:67], v[66:67], v[74:75]
    v_pk_add_f32 v[68:69], v[68:69], v[76:77]
    v_pk_add_f32 v[70:71], v[70:71], v[78:79]
    v_pk_add_f32 v[96:97], v[96:97], v[32:33]
    v_pk_add_f32 v[98:99], v[98:99], v[34:35]
    v_pk_add_f32 v[100:101], v[100:101], v[36:37]
    v_pk_add_f32 v[102:103], v[102:103], v[38:39]
    v_pk_add_f32 v[96:97], v[96:97], v[48:49]
    v_pk_add_f32 v[98:99], v[98:99], v[50:51]
    v_pk_add_f32 v[100:101], v[100:101], v[52:53]
    v_pk_add_f32 v[102:103], v[102:103], v[54:55]
    v_pk_add_f32 v[96:97], v[96:97], v[64:65]
    v_pk_add_f32 v[98:99], v[98:99], v[66:67]
    v_pk_add_f32 v[100:101], v[100:101], v[68:69]
    v_pk_add_f32 v[102:103], v[102:103], v[70:71]
    v_cvt_pk_bf16_f32 v8, v96, v97
    v_cvt_pk_bf16_f32 v9, v98, v99
    v_cvt_pk_bf16_f32 v10, v100, v101
    v_cvt_pk_bf16_f32 v11, v102, v103
    v_min_u32 v8, -2, v8
    v_min_u32 v9, -2, v9
    v_min_u32 v10, -2, v10
    v_min_u32 v11, -2, v11
    s_cmp_ge_u32 s36, 8
    s_cbranch_scc1 L_rok_1
    v_mov_b32 v249, 0
    s_mov_b32 s30, 131072
L_rpoll_2:
    s_sub_u32 s30, s30, 1
    s_cmp_lt_i32 s30, 0
    s_cbranch_scc1 L_rok_1
    global_load_dwordx2 v[242:243], v249, s[18:19] offset:0 sc1
    s_waitcnt vmcnt(0)
    v_readfirstlane_b32 s36, v242
    v_readfirstlane_b32 s37, v243
    s_nop 3
    s_cmp_ge_u32 s36, 8
    s_cbranch_scc1 L_rok_1
    s_sleep 4
    s_branch L_rpoll_2
L_rok_1:
    buffer_store_dwordx4 v[8:11], v5, s[64:67], s28 offen sc1
    s_getreg_b32 s26, hwreg(HW_REG_XCC_ID, 0, 4)
    s_add_u32 s26, s26, s37
    s_lshl_b32 s27, s2, 7
    s_add_u32 s27, s27, 2031616
    v_mov_b32 v250, s26
    v_mov_b32 v249, s27
    s_mov_b64 exec, 1
    buffer_store_dword v250, v249, s[64:67], 0 offen sc1
    s_mov_b64 exec, -1
L_p1_bar2:
    s_barrier
L_spare:
    v_lshrrev_b32 v244, 5, v3
    v_mul_u32_u24 v244, 192, v244
    v_add_u32 v244, v244, v3
    v_mul_u32_u24 v244, 7168, v244
L_vw_3:
    s_cmp_ge_u32 s77, s25
    s_cbranch_scc1 L_vwd_4
    s_mul_i32 s28, s77, 4682
    s_lshr_b32 s28, s28, 16
    s_mul_i32 s29, s28, 14
    s_sub_u32 s29, s77, s29
    s_mul_i32 s29, s29, 5
    s_mul_i32 s26, s29, 4682
    s_lshr_b32 s26, s26, 16
    s_mul_i32 s26, s26, 14
    s_sub_u32 s29, s29, s26
    s_and_b32 s43, s29, 3
    s_lshr_b32 s26, s29, 2
    s_add_u32 s26, s26, s39
    s_cmp_ge_u32 s26, 14
    s_cselect_b32 s27, 14, 0
    s_sub_u32 s26, s26, s27
    s_cmp_ge_u32 s26, 7
    s_cselect_b32 s27, 7, 0
    s_sub_u32 s26, s26, s27
    s_mul_i32 s42, s22, 7
    s_add_u32 s42, s42, s26
    s_lshr_b32 s26, s28, 1
    s_lshr_b32 s27, s29, 2
    s_add_u32 s26, s26, s27
    s_cmp_ge_u32 s26, 14
    s_cselect_b32 s27, 14, 0
    s_sub_u32 s26, s26, s27
    s_cmp_ge_u32 s26, 7
    s_cselect_b32 s27, 7, 0
    s_sub_u32 s26, s26, s27
    s_and_b32 s27, s28, 1
    s_mul_i32 s27, s27, 14
    s_add_u32 s26, s26, s27
    s_mul_i32 s27, s43, 28
    s_add_u32 s26, s26, s27
    s_mul_i32 s26, s26, 229376
    s_lshl_b32 s27, s42, 7
    s_add_u32 s26, s26, s27
    buffer_load_dword v248, v244, s[68:71], s26 offen
    s_add_u32 s77, s77, 8
    s_branch L_vw_3
L_vwd_4:
    s_cmp_ge_u32 s23, 28
    s_cbranch_scc1 L_inbox
    s_load_dwordx2 s[100:101], s[98:99], 50236
    s_add_u32 s98, s97, 6
    s_cmp_ge_u32 s98, 7
    s_cselect_b32 s27, 7, 0
    s_sub_u32 s98, s98, s27
    s_mul_i32 s98, s98, 229376
    s_add_u32 s98, s98, s96
    s_add_u32 s98, s98, s14
    s_addc_u32 s99, s15, 0
    s_load_dwordx2 s[100:101], s[98:99], 60
    s_load_dwordx2 s[100:101], s[98:99], 7228
    s_load_dwordx2 s[100:101], s[98:99], 14396
    s_load_dwordx2 s[100:101], s[98:99], 21564
    s_load_dwordx2 s[100:101], s[98:99], 28732
    s_load_dwordx2 s[100:101], s[98:99], 35900
    s_barrier
    s_add_u32 s26, s49, 0
    s_cmp_ge_u32 s26, 7
    s_cselect_b32 s27, 7, 0
    s_sub_u32 s26, s26, s27
    s_add_u32 m0, s76, 0
    s_mul_i32 s26, s26, 229376
    buffer_load_dwordx4 v254, s[68:71], s26 offen nt lds
    s_add_u32 s26, s49, 0
    s_cmp_ge_u32 s26, 7
    s_cselect_b32 s27, 7, 0
    s_sub_u32 s26, s26, s27
    s_add_u32 m0, s76, 57344
    s_add_u32 s26, s26, 14
    s_mul_i32 s26, s26, 229376
    buffer_load_dwordx4 v254, s[68:71], s26 offen nt lds
    s_add_u32 s26, s49, 1
    s_cmp_ge_u32 s26, 7
    s_cselect_b32 s27, 7, 0
    s_sub_u32 s26, s26, s27
    s_add_u32 m0, s76, 4096
    s_mul_i32 s26, s26, 229376
    buffer_load_dwordx4 v254, s[68:71], s26 offen nt lds
    s_add_u32 s26, s49, 1
    s_cmp_ge_u32 s26, 7
    s_cselect_b32 s27, 7, 0
    s_sub_u32 s26, s26, s27
    s_add_u32 m0, s76, 61440
    s_add_u32 s26, s26, 14
    s_mul_i32 s26, s26, 229376
    buffer_load_dwordx4 v254, s[68:71], s26 offen nt lds
    s_add_u32 s26, s49, 2
    s_cmp_ge_u32 s26, 7
    s_cselect_b32 s27, 7, 0
    s_sub_u32 s26, s26, s27
    s_add_u32 m0, s76, 8192
    s_mul_i32 s26, s26, 229376
    buffer_load_dwordx4 v254, s[68:71], s26 offen nt lds
    s_load_dwordx2 s[100:101], s[98:99], 43068
    s_load_dwordx2 s[100:101], s[98:99], 50236
    s_waitcnt vmcnt(4)
    s_add_u32 s26, s49, 2
    s_cmp_ge_u32 s26, 7
    s_cselect_b32 s27, 7, 0
    s_sub_u32 s26, s26, s27
    s_add_u32 m0, s76, 65536
    s_add_u32 s26, s26, 14
    s_mul_i32 s26, s26, 229376
    buffer_load_dwordx4 v254, s[68:71], s26 offen nt lds
    s_add_u32 s98, s97, 6
    s_cmp_ge_u32 s98, 7
    s_cselect_b32 s27, 7, 0
    s_sub_u32 s98, s98, s27
    s_add_u32 s98, s98, 14
    s_mul_i32 s98, s98, 229376
    s_add_u32 s98, s98, s96
    s_add_u32 s98, s98, s14
    s_addc_u32 s99, s15, 0
    s_load_dwordx2 s[100:101], s[98:99], 60
    s_load_dwordx2 s[100:101], s[98:99], 7228
    s_waitcnt vmcnt(4)
    s_add_u32 s26, s49, 3
    s_cmp_ge_u32 s26, 7
    s_cselect_b32 s27, 7, 0
    s_sub_u32 s26, s26, s27
    s_add_u32 m0, s76, 12288
    s_mul_i32 s26, s26, 229376
    buffer_load_dwordx4 v254, s[68:71], s26 offen nt lds
    s_load_dwordx2 s[100:101], s[98:99], 14396
    s_load_dwordx2 s[100:101], s[98:99], 21564
    s_waitcnt vmcnt(4)
    s_add_u32 s26, s49, 3
    s_cmp_ge_u32 s26, 7
    s_cselect_b32 s27, 7, 0
    s_sub_u32 s26, s26, s27
    s_add_u32 m0, s76, 69632
    s_add_u32 s26, s26, 14
    s_mul_i32 s26, s26, 229376
    buffer_load_dwordx4 v254, s[68:71], s26 offen nt lds
    s_load_dwordx2 s[100:101], s[98:99], 28732
    s_load_dwordx2 s[100:101], s[98:99], 35900
    s_waitcnt vmcnt(4)
    s_add_u32 s26, s49, 4
    s_cmp_ge_u32 s26, 7
    s_cselect_b32 s27, 7, 0
    s_sub_u32 s26, s26, s27
    s_add_u32 m0, s76, 16384
    s_mul_i32 s26, s26, 229376
    buffer_load_dwordx4 v254, s[68:71], s26 offen nt lds
    s_load_dwordx2 s[100:101], s[98:99], 43068
    s_load_dwordx2 s[100:101], s[98:99], 50236
    s_waitcnt vmcnt(4)
    s_add_u32 s26, s49, 4
    s_cmp_ge_u32 s26, 7
    s_cselect_b32 s27, 7, 0
    s_sub_u32 s26, s26, s27
    s_add_u32 m0, s76, 73728
    s_add_u32 s26, s26, 14
    s_mul_i32 s26, s26, 229376
    buffer_load_dwordx4 v254, s[68:71], s26 offen nt lds
    s_waitcnt vmcnt(4)
    s_add_u32 s26, s49, 5
    s_cmp_ge_u32 s26, 7
    s_cselect_b32 s27, 7, 0
    s_sub_u32 s26, s26, s27
    s_add_u32 m0, s76, 20480
    s_mul_i32 s26, s26, 229376
    buffer_load_dwordx4 v254, s[68:71], s26 offen nt lds
    s_waitcnt vmcnt(4)
    s_add_u32 s26, s49, 5
    s_cmp_ge_u32 s26, 7
    s_cselect_b32 s27, 7, 0
    s_sub_u32 s26, s26, s27
    s_add_u32 m0, s76, 77824
    s_add_u32 s26, s26, 14
    s_mul_i32 s26, s26, 229376
    buffer_load_dwordx4 v254, s[68:71], s26 offen nt lds
    s_waitcnt vmcnt(4)
    s_add_u32 s26, s49, 6
    s_cmp_ge_u32 s26, 7
    s_cselect_b32 s27, 7, 0
    s_sub_u32 s26, s26, s27
    s_add_u32 m0, s76, 24576
    s_mul_i32 s26, s26, 229376
    buffer_load_dwordx4 v254, s[68:71], s26 offen nt lds
    s_waitcnt vmcnt(4)
    s_add_u32 s26, s49, 6
    s_cmp_ge_u32 s26, 7
    s_cselect_b32 s27, 7, 0
    s_sub_u32 s26, s26, s27
    s_add_u32 m0, s76, 81920
    s_add_u32 s26, s26, 14
    s_mul_i32 s26, s26, 229376
    buffer_load_dwordx4 v254, s[68:71], s26 offen nt lds
    s_load_dwordx2 s[36:37], s[18:19], 0
    s_load_dword s38, s[18:19], 128
    s_waitcnt lgkmcnt(0)
    s_cmp_ge_u32 s36, 8
    s_cbranch_scc1 L_rok_5
    v_mov_b32 v249, 0
    s_mov_b32 s30, 131072
L_rpoll_6:
    s_sub_u32 s30, s30, 1
    s_cmp_lt_i32 s30, 0
    s_cbranch_scc1 L_rok_5
    global_load_dwordx2 v[242:243], v249, s[18:19] offset:0 sc1
    s_waitcnt vmcnt(0)
    v_readfirstlane_b32 s36, v242
    v_readfirstlane_b32 s37, v243
    s_nop 3
    s_cmp_ge_u32 s36, 8
    s_cbranch_scc1 L_rok_5
    s_sleep 4
    s_branch L_rpoll_6
L_rok_5:
    s_cmp_ge_u32 s38, 16
    s_cbranch_scc1 L_rok_7
    v_mov_b32 v249, 0
    s_mov_b32 s30, 131072
L_rpoll_8:
    s_sub_u32 s30, s30, 1
    s_cmp_lt_i32 s30, 0
    s_cbranch_scc1 L_rok_7
    global_load_dwordx2 v[242:243], v249, s[18:19] offset:128 sc1
    s_waitcnt vmcnt(0)
    v_readfirstlane_b32 s38, v242
    s_nop 3
    s_cmp_ge_u32 s38, 16
    s_cbranch_scc1 L_rok_7
    s_sleep 4
    s_branch L_rpoll_8
L_rok_7:
    s_branch L_p3
L_help:
    s_cmp_ge_u32 s23, 32
    s_cbranch_scc1 L_end
    v_mov_b32 v8, -1
    v_mov_b32 v9, -1
    v_mov_b32 v10, -1
    v_mov_b32 v11, -1
    v_mov_b32 v12, 1
    v_mov_b32 v13, 0
    s_waitcnt lgkmcnt(0)
    s_mov_b32 s64, s20
    s_mov_b32 s65, s21
    s_mov_b32 s66, 0x500000
    s_mov_b32 s67, 0x20000
    s_cmp_ge_u32 s22, 4
    s_cbranch_scc1 L_h2
    s_and_b32 s26, s23, 1
    s_lshl_b32 s26, s26, 2
    s_add_u32 s26, s26, s22
    s_lshl_b32 s26, s26, 3
    s_add_u32 s26, s26, s3
    s_lshl_b32 s27, s26, 11
    v_lshl_add_u32 v4, v3, 4, s27
    buffer_store_dwordx4 v[8:11], v4, s[64:67], 0 offen sc1
    buffer_store_dwordx4 v[8:11], v4, s[64:67], 0 offen offset:1024 sc1
    s_cmp_lg_u32 s26, 15
    s_cbranch_scc1 L_notag
    s_mov_b32 s28, 1966080
    s_load_dword s37, s[20:21], s28
    v_mov_b32 v14, 1966080
    s_waitcnt lgkmcnt(0)
    s_mul_i32 s37, s37, 0x41C64E6D
    s_add_u32 s37, s37, 0x3C6EF35F
    v_mov_b32 v15, s37
    s_mov_b64 exec, 1
    global_store_dword v13, v15, s[18:19] offset:4 sc1
    buffer_store_dword v15, v14, s[64:67], 0 offen sc1
    s_mov_b64 exec, -1
L_notag:
    s_waitcnt vmcnt(0)
    s_barrier
    s_cmp_lg_u32 s3, 0
    s_cbranch_scc1 L_h1
    s_mov_b64 exec, 1
    global_atomic_add v13, v12, s[18:19] sc1
    s_mov_b64 exec, -1
L_h1:
    s_barrier
L_h2:
    s_mov_b32 s52, s20
    s_mov_b32 s53, s21
    s_mov_b32 s54, 0x90000
    s_mov_b32 s55, 0x20000
    s_sub_u32 s26, s2, 240
    s_lshl_b32 s26, s26, 3
    s_add_u32 s26, s26, s3
    s_lshl_b32 s26, s26, 10
    s_add_u32 s26, s26, 131072
    v_lshl_add_u32 v4, v3, 4, s26
    s_mov_b32 s27, 0
    buffer_store_dwordx4 v[8:11], v4, s[52:55], s27 offen sc1
    s_mov_b32 s27, 131072
    buffer_store_dwordx4 v[8:11], v4, s[52:55], s27 offen sc1
    s_mov_b32 s27, 262144
    buffer_store_dwordx4 v[8:11], v4, s[52:55], s27 offen sc1
    s_mov_b32 s27, 393216
    buffer_store_dwordx4 v[8:11], v4, s[52:55], s27 offen sc1
    s_mov_b32 s68, s14
    s_mov_b32 s69, s15
    s_mov_b32 s70, 0x1880000
    s_mov_b32 s71, 0x20000
    s_add_u32 s39, s22, 3
    s_and_b32 s39, s39, 7
    s_and_b32 s48, s23, 3
    s_lshr_b32 s26, s23, 2
    s_add_u32 s26, s26, s39
    s_cmp_ge_u32 s26, 14
    s_cselect_b32 s27, 14, 0
    s_sub_u32 s26, s26, s27
    s_cmp_ge_u32 s26, 7
    s_cselect_b32 s27, 7, 0
    s_sub_u32 s26, s26, s27
    s_mul_i32 s47, s22, 7
    s_add_u32 s47, s47, s26
    s_lshr_b32 s49, s23, 2
    s_lshr_b32 s27, s3, 2
    s_mul_i32 s76, s27, 28672
    s_mul_i32 s26, s27, 224
    s_and_b32 s27, s3, 3
    s_lshl_b32 s27, s27, 3
    s_add_u32 s26, s26, s27
    s_lshl_b32 s27, s27, 7
    s_add_u32 s76, s76, s27
    s_mul_i32 s27, s48, 896
    s_add_u32 s26, s26, s27
    s_mul_i32 s26, s26, 7168
    s_lshl_b32 s27, s47, 7
    s_add_u32 s26, s26, s27
    v_lshrrev_b32 v250, 2, v3
    v_and_b32 v250, 4, v250
    v_xor_b32 v249, v250, v3
    v_and_b32 v249, 7, v249
    v_lshlrev_b32 v249, 4, v249
    v_lshrrev_b32 v250, 3, v3
    v_mul_u32_u24 v250, 7168, v250
    v_add3_u32 v254, v249, v250, s26
    s_waitcnt vmcnt(0)
    s_barrier
    s_cmp_lg_u32 s3, 0
    s_cbranch_scc1 L_h3
    s_mov_b64 exec, 1
    global_atomic_add v13, v12, s[18:19] offset:128 sc1
    s_mov_b64 exec, -1
L_h3:
    s_barrier
    s_sub_u32 s77, s23, 30
    s_mul_i32 s77, s77, 8
    s_add_u32 s77, s77, 0
    s_add_u32 s25, s77, 8
    s_min_u32 s25, s25, 154
    s_add_u32 s77, s77, s3
    v_lshrrev_b32 v244, 5, v3
    v_mul_u32_u24 v244, 192, v244
    v_add_u32 v244, v244, v3
    v_mul_u32_u24 v244, 7168, v244
L_vw_9:
    s_cmp_ge_u32 s77, s25
    s_cbranch_scc1 L_vwd_10
    s_mul_i32 s28, s77, 4682
    s_lshr_b32 s28, s28, 16
    s_mul_i32 s29, s28, 14
    s_sub_u32 s29, s77, s29
    s_mul_i32 s29, s29, 5
    s_mul_i32 s26, s29, 4682
    s_lshr_b32 s26, s26, 16
    s_mul_i32 s26, s26, 14
    s_sub_u32 s29, s29, s26
    s_and_b32 s43, s29, 3
    s_lshr_b32 s26, s29, 2
    s_add_u32 s26, s26, s39
    s_cmp_ge_u32 s26, 14
    s_cselect_b32 s27, 14, 0
    s_sub_u32 s26, s26, s27
    s_cmp_ge_u32 s26, 7
    s_cselect_b32 s27, 7, 0
    s_sub_u32 s26, s26, s27
    s_mul_i32 s42, s22, 7
    s_add_u32 s42, s42, s26
    s_lshr_b32 s26, s28, 1
    s_lshr_b32 s27, s29, 2
    s_add_u32 s26, s26, s27
    s_cmp_ge_u32 s26, 14
    s_cselect_b32 s27, 14, 0
    s_sub_u32 s26, s26, s27
    s_cmp_ge_u32 s26, 7
    s_cselect_b32 s27, 7, 0
    s_sub_u32 s26, s26, s27
    s_and_b32 s27, s28, 1
    s_mul_i32 s27, s27, 14
    s_add_u32 s26, s26, s27
    s_mul_i32 s27, s43, 28
    s_add_u32 s26, s26, s27
    s_mul_i32 s26, s26, 229376
    s_lshl_b32 s27, s42, 7
    s_add_u32 s26, s26, s27
    buffer_load_dword v248, v244, s[68:71], s26 offen
    s_add_u32 s77, s77, 8
    s_branch L_vw_9
L_vwd_10:
    s_barrier
    s_sub_u32 s77, s23, 30
    s_mul_i32 s77, s77, 12
    s_add_u32 s77, s77, 100
    s_add_u32 s25, s77, 12
    s_min_u32 s25, s25, 154
    s_add_u32 s77, s77, s3
    v_lshrrev_b32 v244, 5, v3
    v_mul_u32_u24 v244, 192, v244
    v_add_u32 v244, v244, v3
    v_mul_u32_u24 v244, 7168, v244
L_vw_11:
    s_cmp_ge_u32 s77, s25
    s_cbranch_scc1 L_vwd_12
    s_mul_i32 s28, s77, 4682
    s_lshr_b32 s28, s28, 16
    s_mul_i32 s29, s28, 14
    s_sub_u32 s29, s77, s29
    s_mul_i32 s29, s29, 5
    s_mul_i32 s26, s29, 4682
    s_lshr_b32 s26, s26, 16
    s_mul_i32 s26, s26, 14
    s_sub_u32 s29, s29, s26
    s_and_b32 s43, s29, 3
    s_lshr_b32 s26, s29, 2
    s_add_u32 s26, s26, s39
    s_cmp_ge_u32 s26, 14
    s_cselect_b32 s27, 14, 0
    s_sub_u32 s26, s26, s27
    s_cmp_ge_u32 s26, 7
    s_cselect_b32 s27, 7, 0
    s_sub_u32 s26, s26, s27
    s_mul_i32 s42, s22, 7
    s_add_u32 s42, s42, s26
    s_lshr_b32 s26, s28, 1
    s_lshr_b32 s27, s29, 2
    s_add_u32 s26, s26, s27
    s_cmp_ge_u32 s26, 14
    s_cselect_b32 s27, 14, 0
    s_sub_u32 s26, s26, s27
    s_cmp_ge_u32 s26, 7
    s_cselect_b32 s27, 7, 0
    s_sub_u32 s26, s26, s27
    s_and_b32 s27, s28, 1
    s_mul_i32 s27, s27, 14
    s_add_u32 s26, s26, s27
    s_mul_i32 s27, s43, 28
    s_add_u32 s26, s26, s27
    s_mul_i32 s26, s26, 229376
    s_lshl_b32 s27, s42, 7
    s_add_u32 s26, s26, s27
    buffer_load_dword v248, v244, s[68:71], s26 offen
    s_add_u32 s77, s77, 8
    s_branch L_vw_11
L_vwd_12:
L_inbox:
    s_barrier
    s_and_b32 s77, s23, 3
    s_lshl_b32 s26, s3, 2
    s_add_u32 s77, s77, s26
    s_mov_b32 s25, 28
    v_lshrrev_b32 v244, 5, v3
    v_mul_u32_u24 v244, 192, v244
    v_add_u32 v244, v244, v3
    v_mul_u32_u24 v244, 7168, v244
L_vw_13:
    s_cmp_ge_u32 s77, s25
    s_cbranch_scc1 L_vwd_14
    s_mul_i32 s28, s77, 4682
    s_lshr_b32 s28, s28, 16
    s_mul_i32 s29, s28, 14
    s_sub_u32 s29, s77, s29
    s_add_u32 s29, s29, 14
    s_sub_u32 s28, 13, s28
    s_and_b32 s43, s29, 3
    s_lshr_b32 s26, s29, 2
    s_add_u32 s26, s26, s39
    s_cmp_ge_u32 s26, 14
    s_cselect_b32 s27, 14, 0
    s_sub_u32 s26, s26, s27
    s_cmp_ge_u32 s26, 7
    s_cselect_b32 s27, 7, 0
    s_sub_u32 s26, s26, s27
    s_mul_i32 s42, s22, 7
    s_add_u32 s42, s42, s26
    s_lshr_b32 s26, s28, 1
    s_lshr_b32 s27, s29, 2
    s_add_u32 s26, s26, s27
    s_cmp_ge_u32 s26, 14
    s_cselect_b32 s27, 14, 0
    s_sub_u32 s26, s26, s27
    s_cmp_ge_u32 s26, 7
    s_cselect_b32 s27, 7, 0
    s_sub_u32 s26, s26, s27
    s_and_b32 s27, s28, 1
    s_mul_i32 s27, s27, 14
    s_add_u32 s26, s26, s27
    s_mul_i32 s27, s43, 28
    s_add_u32 s26, s26, s27
    s_mul_i32 s26, s26, 229376
    s_lshl_b32 s27, s42, 7
    s_add_u32 s26, s26, s27
    buffer_load_dword v248, v244, s[68:71], s26 offen
    s_add_u32 s77, s77, 32
    s_branch L_vw_13
L_vwd_14:
    s_barrier
    s_and_b32 s77, s23, 3
    s_mul_i32 s26, s3, 4
    s_add_u32 s77, s77, s26
    s_mul_i32 s26, s22, 344064
    s_add_u32 s26, s26, 2097152
    v_lshl_add_u32 v249, v3, 7, s26
L_inb:
    s_lshl_b32 s26, s77, 13
    buffer_load_dword v248, v249, s[64:67], s26 offen sc1
    s_add_u32 s77, s77, 32
    s_cmp_lt_u32 s77, 42
    s_cbranch_scc1 L_inb
    s_branch L_fin
.p2align 6
L_roleA:
    s_mul_i32 s44, s22, 14
    s_add_u32 s44, s44, s23
    s_and_b32 s45, s23, 3
    s_mul_i32 s26, s3, 1835008
    s_lshl_b32 s27, s44, 7
    s_add_u32 s26, s26, s27
    v_lshrrev_b32 v7, 3, v3
    v_and_b32 v6, 7, v3
    v_mul_u32_u24 v5, 14336, v7
    v_lshl_add_u32 v5, v6, 4, v5
    v_add_u32 v5, s26, v5
    s_mul_i32 s26, s3, 28672
    s_lshl_b32 s27, s44, 6
    s_add_u32 s26, s26, s27
    v_lshl_add_u32 v4, v6, 3, s26
    s_waitcnt lgkmcnt(0)
    s_mov_b32 s52, s6
    s_mov_b32 s53, s7
    s_mov_b32 s54, 0xe00000
    s_mov_b32 s55, 0x20000
    s_mov_b32 s56, s8
    s_mov_b32 s57, s9
    s_mov_b32 s58, 0x38000
    s_mov_b32 s59, 0x20000
    s_mov_b32 s60, s10
    s_mov_b32 s61, s11
    s_mov_b32 s62, 0x38000
    s_mov_b32 s63, 0x20000
    s_xor_b32 s46, s45, 0
    s_mul_i32 s24, s46, 7168
    s_mul_i32 s46, s46, 458752
    buffer_load_dwordx2 v[224:225], v4, s[56:59], s24 offen
    buffer_load_dwordx2 v[226:227], v4, s[60:63], s24 offen
    buffer_load_dwordx4 v[20:23], v5, s[52:55], s46 offen nt
    s_add_u32 s46, s46, 114688
    buffer_load_dwordx4 v[24:27], v5, s[52:55], s46 offen nt
    s_add_u32 s46, s46, 114688
    buffer_load_dwordx4 v[28:31], v5, s[52:55], s46 offen nt
    s_add_u32 s46, s46, 114688
    buffer_load_dwordx4 v[32:35], v5, s[52:55], s46 offen nt
    s_mov_b32 s64, s20
    s_mov_b32 s65, s21
    s_mov_b32 s66, 0x500000
    s_mov_b32 s67, 0x20000
    s_lshl_b32 s28, s3, 13
    s_add_u32 s28, s28, 98304
    v_lshl_add_u32 v212, v3, 3, s28
    v_lshrrev_b32 v6, 1, v2
    v_bfe_u32 v7, v3, 2, 2
    v_lshl_add_u32 v7, v6, 2, v7
    v_lshlrev_b32 v7, 6, v7
    v_and_b32 v8, 1, v2
    v_and_b32 v9, 3, v3
    v_lshl_add_u32 v9, v8, 2, v9
    s_and_b32 s29, s3, 6
    v_xor_b32 v9, s29, v9
    v_lshl_add_u32 v7, v9, 3, v7
    v_add_u32 v214, s28, v7
    v_xor_b32 v215, 0x2000, v214
    s_lshl_b32 s28, s29, 14
    s_and_b32 s29, s3, 1
    s_lshl_b32 s26, s29, 11
    s_add_u32 s28, s28, s26
    v_lshrrev_b32 v7, 1, v1
    v_and_b32 v9, 1, v1
    v_lshlrev_b32 v7, 12, v7
    v_lshl_add_u32 v7, v9, 10, v7
    v_add_u32 v216, s28, v7
    v_lshlrev_b32 v7, 4, v1
    v_lshl_add_u32 v7, v8, 10, v7
    v_mov_b32 v240, v7
    v_lshl_add_u32 v7, v6, 8, v7
    s_lshl_b32 s29, s29, 14
    s_add_u32 s28, s28, s29
    v_add_u32 v218, s28, v7
    v_xor_b32 v219, 0x4000, v218
    v_lshlrev_b32 v7, 4, v3
    s_xor_b32 s28, s3, 0
    s_lshr_b32 s29, s28, 2
    s_mul_i32 s29, s29, 12288
    s_lshl_b32 s28, s28, 12
    s_add_u32 s28, s28, s29
    s_add_u32 s28, s28, 12288
    v_add_u32 v220, s28, v7
    s_xor_b32 s28, s3, 2
    s_lshr_b32 s29, s28, 2
    s_mul_i32 s29, s29, 12288
    s_lshl_b32 s28, s28, 12
    s_add_u32 s28, s28, s29
    s_add_u32 s28, s28, 12288
    v_add_u32 v221, s28, v7
    s_xor_b32 s28, s3, 4
    s_lshr_b32 s29, s28, 2
    s_mul_i32 s29, s29, 12288
    s_lshl_b32 s28, s28, 12
    s_add_u32 s28, s28, s29
    s_add_u32 s28, s28, 13312
    v_add_u32 v222, s28, v7
    s_xor_b32 s28, s3, 6
    s_lshr_b32 s29, s28, 2
    s_mul_i32 s29, s29, 12288
    s_lshl_b32 s28, s28, 12
    s_add_u32 s28, s28, s29
    s_add_u32 s28, s28, 14336
    v_add_u32 v223, s28, v7
    s_mov_b32 s68, s14
    s_mov_b32 s69, s15
    s_mov_b32 s70, 0x1880000
    s_mov_b32 s71, 0x20000
    s_add_u32 s39, s22, 3
    s_and_b32 s39, s39, 7
    s_and_b32 s48, s23, 3
    s_lshr_b32 s26, s23, 2
    s_add_u32 s26, s26, s39
    s_cmp_ge_u32 s26, 14
    s_cselect_b32 s27, 14, 0
    s_sub_u32 s26, s26, s27
    s_cmp_ge_u32 s26, 7
    s_cselect_b32 s27, 7, 0
    s_sub_u32 s26, s26, s27
    s_mul_i32 s47, s22, 7
    s_add_u32 s47, s47, s26
    s_lshr_b32 s49, s23, 2
    s_lshr_b32 s27, s3, 2
    s_mul_i32 s76, s27, 28672
    s_mul_i32 s26, s27, 224
    s_and_b32 s27, s3, 3
    s_lshl_b32 s27, s27, 3
    s_add_u32 s26, s26, s27
    s_lshl_b32 s27, s27, 7
    s_add_u32 s76, s76, s27
    s_mul_i32 s27, s48, 896
    s_add_u32 s26, s26, s27
    s_mul_i32 s26, s26, 7168
    s_lshl_b32 s27, s47, 7
    s_add_u32 s26, s26, s27
    v_lshrrev_b32 v250, 2, v3
    v_and_b32 v250, 4, v250
    v_xor_b32 v249, v250, v3
    v_and_b32 v249, 7, v249
    v_lshlrev_b32 v249, 4, v249
    v_lshrrev_b32 v250, 3, v3
    v_mul_u32_u24 v250, 7168, v250
    v_add3_u32 v254, v249, v250, s26
    s_lshr_b32 s26, s3, 1
    s_and_b32 s29, s3, 1
    s_mul_i32 s27, s48, 28
    s_mul_i32 s28, s26, 7
    s_add_u32 s27, s27, s28
    s_lshl_b32 s27, s27, 1
    s_add_u32 s27, s27, s29
    s_lshl_b32 s27, s27, 11
    s_add_u32 s27, s27, 131072
    v_min_u32 v238, 13, v3
    v_and_b32 v239, 1, v238
    v_lshrrev_b32 v238, 1, v238
    v_lshlrev_b32 v238, 12, v238
    v_lshl_add_u32 v238, v239, 10, v238
    v_add_u32 v253, s27, v238
    v_and_b32 v239, 1, v2
    v_lshrrev_b32 v241, 1, v2
    v_lshlrev_b32 v238, 4, v1
    v_lshl_add_u32 v238, v241, 8, v238
    v_lshl_add_u32 v238, v239, 10, v238
    v_add_u32 v255, s27, v238
    s_add_u32 s4, s49, 0
    s_cmp_ge_u32 s4, 7
    s_cselect_b32 s27, 7, 0
    s_sub_u32 s4, s4, s27
    s_lshl_b32 s4, s4, 12
    s_add_u32 s5, s49, 1
    s_cmp_ge_u32 s5, 7
    s_cselect_b32 s27, 7, 0
    s_sub_u32 s5, s5, s27
    s_lshl_b32 s5, s5, 12
    s_add_u32 s8, s49, 2
    s_cmp_ge_u32 s8, 7
    s_cselect_b32 s27, 7, 0
    s_sub_u32 s8, s8, s27
    s_lshl_b32 s8, s8, 12
    s_add_u32 s9, s49, 3
    s_cmp_ge_u32 s9, 7
    s_cselect_b32 s27, 7, 0
    s_sub_u32 s9, s9, s27
    s_lshl_b32 s9, s9, 12
    s_add_u32 s10, s49, 4
    s_cmp_ge_u32 s10, 7
    s_cselect_b32 s27, 7, 0
    s_sub_u32 s10, s10, s27
    s_lshl_b32 s10, s10, 12
    s_add_u32 s11, s49, 5
    s_cmp_ge_u32 s11, 7
    s_cselect_b32 s27, 7, 0
    s_sub_u32 s11, s11, s27
    s_lshl_b32 s11, s11, 12
    s_add_u32 s12, s49, 6
    s_cmp_ge_u32 s12, 7
    s_cselect_b32 s27, 7, 0
    s_sub_u32 s12, s12, s27
    s_lshl_b32 s12, s12, 12
    v_bfe_u32 v246, v3, 2, 2
    v_lshl_add_u32 v241, v241, 3, v246
    v_lshlrev_b32 v241, 7, v241
    v_and_b32 v246, 2, v246
    v_xor_b32 v239, v239, v246
    v_xor_b32 v239, s26, v239
    v_lshl_add_u32 v241, v239, 5, v241
    v_and_b32 v246, 3, v3
    v_lshl_add_u32 v241, v246, 3, v241
    s_mul_i32 s27, s26, 28672
    v_add_u32 v232, s27, v241
    v_xor_b32 v233, 64, v232
    s_mul_i32 s28, s47, 49152
    s_mul_i32 s27, s29, 6144
    s_add_u32 s28, s28, s27
    s_mul_i32 s27, s26, 12288
    s_add_u32 s28, s28, s27
    s_add_u32 s28, s28, 2097152
    v_lshl_add_u32 v252, v3, 4, s28
    s_sub_u32 s72, s48, s26
    s_sub_u32 s72, s72, 1
    s_and_b32 s72, s72, 3
    s_lshl_b32 s72, s72, 11
    s_movk_i32 s74, 4096
    s_xor_b32 s75, s26, s48
    v_mov_b32 v245, 0xffffff00
    v_lshlrev_b32 v239, 4, v3
    s_xor_b32 s27, s3, 0
    s_mul_i32 s27, s27, 6144
    s_add_u32 s27, s27, 114688
    v_add_u32 v234, s27, v239
    s_xor_b32 s27, s3, 2
    s_mul_i32 s27, s27, 6144
    s_add_u32 s27, s27, 114688
    v_add_u32 v235, s27, v239
    s_xor_b32 s27, s3, 4
    s_mul_i32 s27, s27, 6144
    s_add_u32 s27, s27, 116736
    v_add_u32 v236, s27, v239
    s_xor_b32 s27, s3, 6
    s_mul_i32 s27, s27, 6144
    s_add_u32 s27, s27, 118784
    v_add_u32 v237, s27, v239
    s_mul_i32 s28, s29, 229376
    s_lshl_b32 s27, s47, 7
    s_add_u32 s28, s28, s27
    s_lshl_b32 s27, s48, 5
    s_add_u32 s28, s28, s27
    v_and_b32 v241, 31, v3
    v_mul_u32_u24 v241, 7168, v241
    v_lshrrev_b32 v246, 5, v3
    v_lshl_add_u32 v241, v246, 4, v241
    v_add_u32 v251, s28, v241
    s_and_b32 s13, s23, 28
    s_add_u32 s13, s13, s26
    s_lshl_b32 s13, s13, 3
    s_add_u32 s13, s13, s22
    s_lshl_b32 s13, s13, 7
    s_add_u32 s13, s13, 2031616
    s_xor_b32 s40, s45, 0
    s_lshl_b32 s40, s40, 12
    s_xor_b32 s41, s45, 1
    s_lshl_b32 s41, s41, 12
    s_xor_b32 s42, s45, 2
    s_lshl_b32 s42, s42, 12
    s_xor_b32 s43, s45, 3
    s_lshl_b32 s43, s43, 12
    s_waitcnt vmcnt(5)
    s_xor_b32 s46, s45, 1
    s_mul_i32 s24, s46, 7168
    s_mul_i32 s46, s46, 458752
    buffer_load_dwordx2 v[228:229], v4, s[56:59], s24 offen
    s_waitcnt vmcnt(5)
    buffer_load_dwordx2 v[230:231], v4, s[60:63], s24 offen
    s_waitcnt vmcnt(5)
    buffer_load_dwordx4 v[36:39], v5, s[52:55], s46 offen nt
    s_add_u32 s46, s46, 114688
    v_lshlrev_b32 v12, 16, v224
    v_and_b32 v13, 0xffff0000, v224
    v_lshlrev_b32 v16, 16, v226
    v_and_b32 v17, 0xffff0000, v226
    v_lshlrev_b32 v14, 16, v225
    v_and_b32 v15, 0xffff0000, v225
    v_lshlrev_b32 v18, 16, v227
    v_and_b32 v19, 0xffff0000, v227
    v_pk_mul_f32 v[16:17], v[16:17], v[12:13]
    v_pk_mul_f32 v[18:19], v[18:19], v[14:15]
    v_cvt_f32_i32 v20, v20
    v_cvt_f32_i32 v21, v21
    v_cvt_f32_i32 v22, v22
    v_cvt_f32_i32 v23, v23
    v_pk_fma_f32 v[20:21], v[20:21], v[12:13], v[16:17] neg_lo:[0,0,1] neg_hi:[0,0,1]
    v_pk_fma_f32 v[22:23], v[22:23], v[14:15], v[18:19] neg_lo:[0,0,1] neg_hi:[0,0,1]
    v_cvt_pk_bf16_f32 v20, v20, v21
    v_cvt_pk_bf16_f32 v21, v22, v23
    ds_write_b64 v212, v[20:21] offset:0
    s_waitcnt vmcnt(5)
    buffer_load_dwordx4 v[40:43], v5, s[52:55], s46 offen nt
    s_add_u32 s46, s46, 114688
    v_cvt_f32_i32 v24, v24
    v_cvt_f32_i32 v25, v25
    v_cvt_f32_i32 v26, v26
    v_cvt_f32_i32 v27, v27
    v_pk_fma_f32 v[24:25], v[24:25], v[12:13], v[16:17] neg_lo:[0,0,1] neg_hi:[0,0,1]
    v_pk_fma_f32 v[26:27], v[26:27], v[14:15], v[18:19] neg_lo:[0,0,1] neg_hi:[0,0,1]
    v_cvt_pk_bf16_f32 v24, v24, v25
    v_cvt_pk_bf16_f32 v25, v26, v27
    ds_write_b64 v212, v[24:25] offset:512
    s_waitcnt vmcnt(5)
    buffer_load_dwordx4 v[44:47], v5, s[52:55], s46 offen nt
    s_add_u32 s46, s46, 114688
    v_cvt_f32_i32 v28, v28
    v_cvt_f32_i32 v29, v29
    v_cvt_f32_i32 v30, v30
    v_cvt_f32_i32 v31, v31
    v_pk_fma_f32 v[28:29], v[28:29], v[12:13], v[16:17] neg_lo:[0,0,1] neg_hi:[0,0,1]
    v_pk_fma_f32 v[30:31], v[30:31], v[14:15], v[18:19] neg_lo:[0,0,1] neg_hi:[0,0,1]
    v_cvt_pk_bf16_f32 v28, v28, v29
    v_cvt_pk_bf16_f32 v29, v30, v31
    ds_write_b64 v212, v[28:29] offset:1024
    s_waitcnt vmcnt(5)
    buffer_load_dwordx4 v[48:51], v5, s[52:55], s46 offen nt
    v_cvt_f32_i32 v32, v32
    v_cvt_f32_i32 v33, v33
    v_cvt_f32_i32 v34, v34
    v_cvt_f32_i32 v35, v35
    v_pk_fma_f32 v[32:33], v[32:33], v[12:13], v[16:17] neg_lo:[0,0,1] neg_hi:[0,0,1]
    v_pk_fma_f32 v[34:35], v[34:35], v[14:15], v[18:19] neg_lo:[0,0,1] neg_hi:[0,0,1]
    v_cvt_pk_bf16_f32 v32, v32, v33
    v_cvt_pk_bf16_f32 v33, v34, v35
    ds_write_b64 v212, v[32:33] offset:1536
    ds_read_b64_tr_b16 v[84:85], v214 offset:0
    ds_read_b64_tr_b16 v[86:87], v214 offset:1024
    ds_read_b64_tr_b16 v[88:89], v214 offset:512
    ds_read_b64_tr_b16 v[90:91], v214 offset:1536
    s_waitcnt vmcnt(5)
    s_xor_b32 s46, s45, 2
    s_mul_i32 s24, s46, 7168
    s_mul_i32 s46, s46, 458752
    buffer_load_dwordx2 v[224:225], v4, s[56:59], s24 offen
    s_waitcnt vmcnt(5)
    buffer_load_dwordx2 v[226:227], v4, s[60:63], s24 offen
    s_waitcnt vmcnt(5)
    buffer_load_dwordx4 v[52:55], v5, s[52:55], s46 offen nt
    s_add_u32 s46, s46, 114688
    v_lshlrev_b32 v12, 16, v228
    v_and_b32 v13, 0xffff0000, v228
    v_lshlrev_b32 v16, 16, v230
    v_and_b32 v17, 0xffff0000, v230
    v_lshlrev_b32 v14, 16, v229
    v_and_b32 v15, 0xffff0000, v229
    v_lshlrev_b32 v18, 16, v231
    v_and_b32 v19, 0xffff0000, v231
    v_pk_mul_f32 v[16:17], v[16:17], v[12:13]
    v_pk_mul_f32 v[18:19], v[18:19], v[14:15]
    v_cvt_f32_i32 v36, v36
    v_cvt_f32_i32 v37, v37
    v_cvt_f32_i32 v38, v38
    v_cvt_f32_i32 v39, v39
    v_pk_fma_f32 v[36:37], v[36:37], v[12:13], v[16:17] neg_lo:[0,0,1] neg_hi:[0,0,1]
    v_pk_fma_f32 v[38:39], v[38:39], v[14:15], v[18:19] neg_lo:[0,0,1] neg_hi:[0,0,1]
    v_cvt_pk_bf16_f32 v36, v36, v37
    v_cvt_pk_bf16_f32 v37, v38, v39
    ds_write_b64 v212, v[36:37] offset:2048
    s_waitcnt vmcnt(5)
    buffer_load_dwordx4 v[56:59], v5, s[52:55], s46 offen nt
    s_add_u32 s46, s46, 114688
    v_cvt_f32_i32 v40, v40
    v_cvt_f32_i32 v41, v41
    v_cvt_f32_i32 v42, v42
    v_cvt_f32_i32 v43, v43
    v_pk_fma_f32 v[40:41], v[40:41], v[12:13], v[16:17] neg_lo:[0,0,1] neg_hi:[0,0,1]
    v_pk_fma_f32 v[42:43], v[42:43], v[14:15], v[18:19] neg_lo:[0,0,1] neg_hi:[0,0,1]
    v_cvt_pk_bf16_f32 v40, v40, v41
    v_cvt_pk_bf16_f32 v41, v42, v43
    ds_write_b64 v212, v[40:41] offset:2560
    s_waitcnt vmcnt(5)
    buffer_load_dwordx4 v[60:63], v5, s[52:55], s46 offen nt
    s_add_u32 s46, s46, 114688
    v_cvt_f32_i32 v44, v44
    v_cvt_f32_i32 v45, v45
    v_cvt_f32_i32 v46, v46
    v_cvt_f32_i32 v47, v47
    v_pk_fma_f32 v[44:45], v[44:45], v[12:13], v[16:17] neg_lo:[0,0,1] neg_hi:[0,0,1]
    v_pk_fma_f32 v[46:47], v[46:47], v[14:15], v[18:19] neg_lo:[0,0,1] neg_hi:[0,0,1]
    v_cvt_pk_bf16_f32 v44, v44, v45
    v_cvt_pk_bf16_f32 v45, v46, v47
    ds_write_b64 v212, v[44:45] offset:3072
    s_waitcnt vmcnt(5)
    buffer_load_dwordx4 v[64:67], v5, s[52:55], s46 offen nt
    v_cvt_f32_i32 v48, v48
    v_cvt_f32_i32 v49, v49
    v_cvt_f32_i32 v50, v50
    v_cvt_f32_i32 v51, v51
    v_pk_fma_f32 v[48:49], v[48:49], v[12:13], v[16:17] neg_lo:[0,0,1] neg_hi:[0,0,1]
    v_pk_fma_f32 v[50:51], v[50:51], v[14:15], v[18:19] neg_lo:[0,0,1] neg_hi:[0,0,1]
    v_cvt_pk_bf16_f32 v48, v48, v49
    v_cvt_pk_bf16_f32 v49, v50, v51
    ds_write_b64 v212, v[48:49] offset:3584
    ds_read_b64_tr_b16 v[92:93], v214 offset:2048
    ds_read_b64_tr_b16 v[94:95], v214 offset:3072
    ds_read_b64_tr_b16 v[96:97], v214 offset:2560
    ds_read_b64_tr_b16 v[98:99], v214 offset:3584
    s_waitcnt vmcnt(5)
    s_xor_b32 s46, s45, 3
    s_mul_i32 s24, s46, 7168
    s_mul_i32 s46, s46, 458752
    buffer_load_dwordx2 v[228:229], v4, s[56:59], s24 offen
    s_waitcnt vmcnt(5)
    buffer_load_dwordx2 v[230:231], v4, s[60:63], s24 offen
    s_waitcnt vmcnt(5)
    buffer_load_dwordx4 v[68:71], v5, s[52:55], s46 offen
    s_add_u32 s46, s46, 114688
    v_lshlrev_b32 v12, 16, v224
    v_and_b32 v13, 0xffff0000, v224
    v_lshlrev_b32 v16, 16, v226
    v_and_b32 v17, 0xffff0000, v226
    v_lshlrev_b32 v14, 16, v225
    v_and_b32 v15, 0xffff0000, v225
    v_lshlrev_b32 v18, 16, v227
    v_and_b32 v19, 0xffff0000, v227
    v_pk_mul_f32 v[16:17], v[16:17], v[12:13]
    v_pk_mul_f32 v[18:19], v[18:19], v[14:15]
    v_cvt_f32_i32 v52, v52
    v_cvt_f32_i32 v53, v53
    v_cvt_f32_i32 v54, v54
    v_cvt_f32_i32 v55, v55
    v_pk_fma_f32 v[52:53], v[52:53], v[12:13], v[16:17] neg_lo:[0,0,1] neg_hi:[0,0,1]
    v_pk_fma_f32 v[54:55], v[54:55], v[14:15], v[18:19] neg_lo:[0,0,1] neg_hi:[0,0,1]
    v_cvt_pk_bf16_f32 v52, v52, v53
    v_cvt_pk_bf16_f32 v53, v54, v55
    ds_write_b64 v212, v[52:53] offset:4096
    s_waitcnt vmcnt(5)
    buffer_load_dwordx4 v[72:75], v5, s[52:55], s46 offen
    s_add_u32 s46, s46, 114688
    v_cvt_f32_i32 v56, v56
    v_cvt_f32_i32 v57, v57
    v_cvt_f32_i32 v58, v58
    v_cvt_f32_i32 v59, v59
    v_pk_fma_f32 v[56:57], v[56:57], v[12:13], v[16:17] neg_lo:[0,0,1] neg_hi:[0,0,1]
    v_pk_fma_f32 v[58:59], v[58:59], v[14:15], v[18:19] neg_lo:[0,0,1] neg_hi:[0,0,1]
    v_cvt_pk_bf16_f32 v56, v56, v57
    v_cvt_pk_bf16_f32 v57, v58, v59
    ds_write_b64 v212, v[56:57] offset:4608
    s_waitcnt vmcnt(5)
    buffer_load_dwordx4 v[76:79], v5, s[52:55], s46 offen
    s_add_u32 s46, s46, 114688
    v_cvt_f32_i32 v60, v60
    v_cvt_f32_i32 v61, v61
    v_cvt_f32_i32 v62, v62
    v_cvt_f32_i32 v63, v63
    v_pk_fma_f32 v[60:61], v[60:61], v[12:13], v[16:17] neg_lo:[0,0,1] neg_hi:[0,0,1]
    v_pk_fma_f32 v[62:63], v[62:63], v[14:15], v[18:19] neg_lo:[0,0,1] neg_hi:[0,0,1]
    v_cvt_pk_bf16_f32 v60, v60, v61
    v_cvt_pk_bf16_f32 v61, v62, v63
    ds_write_b64 v212, v[60:61] offset:5120
    s_waitcnt vmcnt(5)
    buffer_load_dwordx4 v[80:83], v5, s[52:55], s46 offen
    v_cvt_f32_i32 v64, v64
    v_cvt_f32_i32 v65, v65
    v_cvt_f32_i32 v66, v66
    v_cvt_f32_i32 v67, v67
    v_pk_fma_f32 v[64:65], v[64:65], v[12:13], v[16:17] neg_lo:[0,0,1] neg_hi:[0,0,1]
    v_pk_fma_f32 v[66:67], v[66:67], v[14:15], v[18:19] neg_lo:[0,0,1] neg_hi:[0,0,1]
    v_cvt_pk_bf16_f32 v64, v64, v65
    v_cvt_pk_bf16_f32 v65, v66, v67
    ds_write_b64 v212, v[64:65] offset:5632
    ds_read_b64_tr_b16 v[100:101], v214 offset:4096
    ds_read_b64_tr_b16 v[102:103], v214 offset:5120
    ds_read_b64_tr_b16 v[104:105], v214 offset:4608
    ds_read_b64_tr_b16 v[106:107], v214 offset:5632
    s_waitcnt vmcnt(5)
    s_waitcnt vmcnt(4)
    s_waitcnt vmcnt(3)
    v_lshlrev_b32 v12, 16, v228
    v_and_b32 v13, 0xffff0000, v228
    v_lshlrev_b32 v16, 16, v230
    v_and_b32 v17, 0xffff0000, v230
    v_lshlrev_b32 v14, 16, v229
    v_and_b32 v15, 0xffff0000, v229
    v_lshlrev_b32 v18, 16, v231
    v_and_b32 v19, 0xffff0000, v231
    v_pk_mul_f32 v[16:17], v[16:17], v[12:13]
    v_pk_mul_f32 v[18:19], v[18:19], v[14:15]
    v_cvt_f32_i32 v68, v68
    v_cvt_f32_i32 v69, v69
    v_cvt_f32_i32 v70, v70
    v_cvt_f32_i32 v71, v71
    v_pk_fma_f32 v[68:69], v[68:69], v[12:13], v[16:17] neg_lo:[0,0,1] neg_hi:[0,0,1]
    v_pk_fma_f32 v[70:71], v[70:71], v[14:15], v[18:19] neg_lo:[0,0,1] neg_hi:[0,0,1]
    v_cvt_pk_bf16_f32 v68, v68, v69
    v_cvt_pk_bf16_f32 v69, v70, v71
    ds_write_b64 v212, v[68:69] offset:6144
    s_load_dwordx2 s[36:37], s[18:19], 0
    s_waitcnt vmcnt(2)
    v_cvt_f32_i32 v72, v72
    v_cvt_f32_i32 v73, v73
    v_cvt_f32_i32 v74, v74
    v_cvt_f32_i32 v75, v75
    v_pk_fma_f32 v[72:73], v[72:73], v[12:13], v[16:17] neg_lo:[0,0,1] neg_hi:[0,0,1]
    v_pk_fma_f32 v[74:75], v[74:75], v[14:15], v[18:19] neg_lo:[0,0,1] neg_hi:[0,0,1]
    v_cvt_pk_bf16_f32 v72, v72, v73
    v_cvt_pk_bf16_f32 v73, v74, v75
    ds_write_b64 v212, v[72:73] offset:6656
    s_waitcnt vmcnt(1)
    v_cvt_f32_i32 v76, v76
    v_cvt_f32_i32 v77, v77
    v_cvt_f32_i32 v78, v78
    v_cvt_f32_i32 v79, v79
    v_pk_fma_f32 v[76:77], v[76:77], v[12:13], v[16:17] neg_lo:[0,0,1] neg_hi:[0,0,1]
    v_pk_fma_f32 v[78:79], v[78:79], v[14:15], v[18:19] neg_lo:[0,0,1] neg_hi:[0,0,1]
    v_cvt_pk_bf16_f32 v76, v76, v77
    v_cvt_pk_bf16_f32 v77, v78, v79
    ds_write_b64 v212, v[76:77] offset:7168
    s_waitcnt lgkmcnt(0)
    s_cmp_ge_u32 s36, 8
    s_cbranch_scc1 L_rok_15
    v_mov_b32 v249, 0
    s_mov_b32 s30, 131072
L_rpoll_16:
    s_sub_u32 s30, s30, 1
    s_cmp_lt_i32 s30, 0
    s_cbranch_scc1 L_rok_15
    global_load_dwordx2 v[242:243], v249, s[18:19] offset:0 sc1
    s_waitcnt vmcnt(0)
    v_readfirstlane_b32 s36, v242
    v_readfirstlane_b32 s37, v243
    s_nop 3
    s_cmp_ge_u32 s36, 8
    s_cbranch_scc1 L_rok_15
    s_sleep 4
    s_branch L_rpoll_16
L_rok_15:
    buffer_load_dwordx4 v[148:151], v218, s[64:67], s40 offen sc1
    buffer_load_dwordx4 v[152:155], v218, s[64:67], s40 offen offset:512 sc1
    buffer_load_dwordx4 v[156:159], v218, s[64:67], s41 offen sc1
    buffer_load_dwordx4 v[160:163], v218, s[64:67], s41 offen offset:512 sc1
    buffer_load_dwordx4 v[164:167], v218, s[64:67], s42 offen sc1
    s_waitcnt vmcnt(5)
    v_cvt_f32_i32 v80, v80
    v_cvt_f32_i32 v81, v81
    v_cvt_f32_i32 v82, v82
    v_cvt_f32_i32 v83, v83
    v_pk_fma_f32 v[80:81], v[80:81], v[12:13], v[16:17] neg_lo:[0,0,1] neg_hi:[0,0,1]
    v_pk_fma_f32 v[82:83], v[82:83], v[14:15], v[18:19] neg_lo:[0,0,1] neg_hi:[0,0,1]
    v_cvt_pk_bf16_f32 v80, v80, v81
    v_cvt_pk_bf16_f32 v81, v82, v83
    ds_write_b64 v212, v[80:81] offset:7680
    ds_read_b64_tr_b16 v[108:109], v214 offset:6144
    ds_read_b64_tr_b16 v[110:111], v214 offset:7168
    ds_read_b64_tr_b16 v[112:113], v214 offset:6656
    ds_read_b64_tr_b16 v[114:115], v214 offset:7680
    s_waitcnt lgkmcnt(0)
    s_barrier
    ds_read_b64_tr_b16 v[116:117], v215 offset:0
    ds_read_b64_tr_b16 v[118:119], v215 offset:1024
    ds_read_b64_tr_b16 v[120:121], v215 offset:512
    ds_read_b64_tr_b16 v[122:123], v215 offset:1536
    ds_read_b64_tr_b16 v[124:125], v215 offset:2048
    ds_read_b64_tr_b16 v[126:127], v215 offset:3072
    ds_read_b64_tr_b16 v[128:129], v215 offset:2560
    ds_read_b64_tr_b16 v[130:131], v215 offset:3584
    ds_read_b64_tr_b16 v[132:133], v215 offset:4096
    ds_read_b64_tr_b16 v[134:135], v215 offset:5120
    ds_read_b64_tr_b16 v[136:137], v215 offset:4608
    ds_read_b64_tr_b16 v[138:139], v215 offset:5632
    ds_read_b64_tr_b16 v[140:141], v215 offset:6144
    ds_read_b64_tr_b16 v[142:143], v215 offset:7168
    ds_read_b64_tr_b16 v[144:145], v215 offset:6656
    ds_read_b64_tr_b16 v[146:147], v215 offset:7680
    s_mov_b32 s30, 131072
    s_branch L_p2_run
L_p2_poll:
    buffer_load_dword v217, v216, s[64:67], 0 offen sc1
    s_sleep 1
L_p2_chk:
    s_waitcnt vmcnt(0)
    v_cmp_eq_u32 vcc, -1, v217
    s_cbranch_vccz L_p2_go
    s_sub_u32 s30, s30, 1
    s_cmp_ge_i32 s30, 0
    s_cbranch_scc1 L_p2_poll
L_p2_go:
    buffer_load_dwordx4 v[148:151], v218, s[64:67], s40 offen sc1
    buffer_load_dwordx4 v[152:155], v218, s[64:67], s40 offen offset:512 sc1
    buffer_load_dwordx4 v[156:159], v218, s[64:67], s41 offen sc1
    buffer_load_dwordx4 v[160:163], v218, s[64:67], s41 offen offset:512 sc1
    buffer_load_dwordx4 v[164:167], v218, s[64:67], s42 offen sc1
L_p2_run:
    s_waitcnt vmcnt(4)
    buffer_load_dwordx4 v[168:171], v218, s[64:67], s42 offen offset:512 sc1
    v_mfma_f32_32x32x16_bf16 v[20:35], v[84:87], v[148:151], 0
    v_max3_u32 v213, v148, v149, v150
    v_max_u32 v213, v213, v151
    s_waitcnt vmcnt(4)
    buffer_load_dwordx4 v[172:175], v218, s[64:67], s43 offen sc1
    v_mfma_f32_32x32x16_bf16 v[20:35], v[88:91], v[152:155], v[20:35]
    v_max3_u32 v213, v213, v152, v153
    v_max3_u32 v213, v213, v154, v155
    v_cmp_eq_u32 vcc, -1, v213
    s_cbranch_vccnz L_p2_bad
    s_waitcnt vmcnt(4)
    buffer_load_dwordx4 v[176:179], v218, s[64:67], s43 offen offset:512 sc1
    v_mfma_f32_32x32x16_bf16 v[20:35], v[92:95], v[156:159], v[20:35]
    v_max3_u32 v213, v213, v156, v157
    v_max3_u32 v213, v213, v158, v159
    s_waitcnt vmcnt(4)
    buffer_load_dwordx4 v[180:183], v219, s[64:67], s40 offen sc1
    v_mfma_f32_32x32x16_bf16 v[20:35], v[96:99], v[160:163], v[20:35]
    v_max3_u32 v213, v213, v160, v161
    v_max3_u32 v213, v213, v162, v163
    s_waitcnt vmcnt(4)
    buffer_load_dwordx4 v[184:187], v219, s[64:67], s40 offen offset:512 sc1
    v_mfma_f32_32x32x16_bf16 v[20:35], v[100:103], v[164:167], v[20:35]
    v_max3_u32 v213, v213, v164, v165
    v_max3_u32 v213, v213, v166, v167
    s_waitcnt vmcnt(4)
    buffer_load_dwordx4 v[188:191], v219, s[64:67], s41 offen sc1
    v_mfma_f32_32x32x16_bf16 v[20:35], v[104:107], v[168:171], v[20:35]
    v_max3_u32 v213, v213, v168, v169
    v_max3_u32 v213, v213, v170, v171
    v_cmp_eq_u32 vcc, -1, v213
    s_cbranch_vccnz L_p2_bad
    s_waitcnt vmcnt(4)
    buffer_load_dwordx4 v[192:195], v219, s[64:67], s41 offen offset:512 sc1
    v_mfma_f32_32x32x16_bf16 v[20:35], v[108:111], v[172:175], v[20:35]
    v_max3_u32 v213, v213, v172, v173
    v_max3_u32 v213, v213, v174, v175
    s_waitcnt vmcnt(4)
    buffer_load_dwordx4 v[196:199], v219, s[64:67], s42 offen sc1
    v_mfma_f32_32x32x16_bf16 v[20:35], v[112:115], v[176:179], v[20:35]
    v_max3_u32 v213, v213, v176, v177
    v_max3_u32 v213, v213, v178, v179
    s_waitcnt vmcnt(4)
    buffer_load_dwordx4 v[200:203], v219, s[64:67], s42 offen offset:512 sc1
    s_waitcnt lgkmcnt(0)
    s_load_dword s38, s[18:19], 128
    v_mfma_f32_32x32x16_bf16 v[20:35], v[116:119], v[180:183], v[20:35]
    v_max3_u32 v213, v213, v180, v181
    v_max3_u32 v213, v213, v182, v183
    s_waitcnt vmcnt(4)
    buffer_load_dwordx4 v[204:207], v219, s[64:67], s43 offen sc1
    v_mfma_f32_32x32x16_bf16 v[20:35], v[120:123], v[184:187], v[20:35]
    v_max3_u32 v213, v213, v184, v185
    v_max3_u32 v213, v213, v186, v187
    v_cmp_eq_u32 vcc, -1, v213
    s_cbranch_vccnz L_p2_bad
    s_waitcnt vmcnt(4)
    buffer_load_dwordx4 v[208:211], v219, s[64:67], s43 offen offset:512 sc1
    v_mfma_f32_32x32x16_bf16 v[20:35], v[124:127], v[188:191], v[20:35]
    v_max3_u32 v213, v213, v188, v189
    v_max3_u32 v213, v213, v190, v191
    s_waitcnt vmcnt(4)
    v_mfma_f32_32x32x16_bf16 v[20:35], v[128:131], v[192:195], v[20:35]
    v_max3_u32 v213, v213, v192, v193
    v_max3_u32 v213, v213, v194, v195
    s_waitcnt vmcnt(3)
    v_mfma_f32_32x32x16_bf16 v[20:35], v[132:135], v[196:199], v[20:35]
    v_max3_u32 v213, v213, v196, v197
    v_max3_u32 v213, v213, v198, v199
    s_waitcnt vmcnt(2)
    v_mfma_f32_32x32x16_bf16 v[20:35], v[136:139], v[200:203], v[20:35]
    v_max3_u32 v213, v213, v200, v201
    v_max3_u32 v213, v213, v202, v203
    s_waitcnt vmcnt(1)
    v_mfma_f32_32x32x16_bf16 v[20:35], v[140:143], v[204:207], v[20:35]
    v_max3_u32 v213, v213, v204, v205
    v_max3_u32 v213, v213, v206, v207
    s_waitcnt vmcnt(0)
    v_mfma_f32_32x32x16_bf16 v[20:35], v[144:147], v[208:211], v[20:35]
    v_max3_u32 v213, v213, v208, v209
    v_max3_u32 v213, v213, v210, v211
    v_cmp_eq_u32 vcc, -1, v213
    s_cbranch_vccz L_p2_ok
L_p2_bad:
    s_sub_u32 s30, s30, 1
    s_cmp_lt_i32 s30, 0
    s_cbranch_scc1 L_p2_ok
    s_branch L_p2_poll
L_p2_ok:
    s_lshl_b32 s28, s44, 12
    s_and_b32 s26, s3, 1
    s_lshl_b32 s26, s26, 11
    s_add_u32 s28, s28, s26
    s_lshr_b32 s26, s3, 1
    s_lshl_b32 s26, s26, 8
    s_add_u32 s28, s28, s26
    s_add_u32 s28, s28, 131072
    s_nop 1
    ds_write_b128 v221, v[24:27]
    ds_write_b128 v222, v[28:31]
    ds_write_b128 v223, v[32:35]
    s_waitcnt lgkmcnt(0)
    s_cmp_ge_u32 s38, 16
    s_cbranch_scc1 L_rok_17
    v_mov_b32 v249, 0
    s_mov_b32 s30, 131072
L_rpoll_18:
    s_sub_u32 s30, s30, 1
    s_cmp_lt_i32 s30, 0
    s_cbranch_scc1 L_rok_17
    global_load_dwordx2 v[242:243], v249, s[18:19] offset:128 sc1
    s_waitcnt vmcnt(0)
    v_readfirstlane_b32 s38, v242
    s_nop 3
    s_cmp_ge_u32 s38, 16
    s_cbranch_scc1 L_rok_17
    s_sleep 4
    s_branch L_rpoll_18
L_rok_17:
    s_barrier
    ds_read_b128 v[24:27], v220 offset:0
    ds_read_b128 v[28:31], v220 offset:1024
    ds_read_b128 v[32:35], v220 offset:2048
    s_waitcnt lgkmcnt(2)
    v_pk_add_f32 v[20:21], v[20:21], v[24:25]
    v_pk_add_f32 v[22:23], v[22:23], v[26:27]
    s_waitcnt lgkmcnt(1)
    v_pk_add_f32 v[20:21], v[20:21], v[28:29]
    v_pk_add_f32 v[22:23], v[22:23], v[30:31]
    s_waitcnt lgkmcnt(0)
    v_pk_add_f32 v[20:21], v[20:21], v[32:33]
    v_pk_add_f32 v[22:23], v[22:23], v[34:35]
    v_cvt_pk_bf16_f32 v8, v20, v21
    v_cvt_pk_bf16_f32 v9, v22, v23
    v_min_u32 v8, -2, v8
    v_min_u32 v9, -2, v9
    v_mov_b32 v10, v8
    v_mov_b32 v11, v9
    s_nop 1
    v_permlane32_swap_b32 v8, v10
    v_permlane32_swap_b32 v9, v11
    s_mov_b32 exec_hi, 0
    buffer_store_dwordx4 v[8:11], v240, s[64:67], s28 offen sc1
    s_mov_b32 exec_hi, -1
    s_cmp_lg_u32 s3, 7
    s_cbranch_scc1 L_p2_hi
    s_getreg_b32 s26, hwreg(HW_REG_XCC_ID, 0, 4)
    s_add_u32 s26, s26, s37
    s_lshl_b32 s27, s2, 7
    s_add_u32 s27, s27, 2031616
    v_mov_b32 v250, s26
    v_mov_b32 v249, s27
    s_mov_b64 exec, 1
    buffer_store_dword v250, v249, s[64:67], 0 offen sc1
    s_mov_b64 exec, -1
L_p2_hi:
    s_barrier
    s_add_u32 s26, s49, 0
    s_cmp_ge_u32 s26, 7
    s_cselect_b32 s27, 7, 0
    s_sub_u32 s26, s26, s27
    s_add_u32 m0, s76, 0
    s_mul_i32 s26, s26, 229376
    buffer_load_dwordx4 v254, s[68:71], s26 offen nt lds
    s_add_u32 s26, s49, 0
    s_cmp_ge_u32 s26, 7
    s_cselect_b32 s27, 7, 0
    s_sub_u32 s26, s26, s27
    s_add_u32 m0, s76, 57344
    s_add_u32 s26, s26, 14
    s_mul_i32 s26, s26, 229376
    buffer_load_dwordx4 v254, s[68:71], s26 offen nt lds
    s_add_u32 s26, s49, 1
    s_cmp_ge_u32 s26, 7
    s_cselect_b32 s27, 7, 0
    s_sub_u32 s26, s26, s27
    s_add_u32 m0, s76, 4096
    s_mul_i32 s26, s26, 229376
    buffer_load_dwordx4 v254, s[68:71], s26 offen nt lds
    s_add_u32 s26, s49, 1
    s_cmp_ge_u32 s26, 7
    s_cselect_b32 s27, 7, 0
    s_sub_u32 s26, s26, s27
    s_add_u32 m0, s76, 61440
    s_add_u32 s26, s26, 14
    s_mul_i32 s26, s26, 229376
    buffer_load_dwordx4 v254, s[68:71], s26 offen nt lds
    s_add_u32 s26, s49, 2
    s_cmp_ge_u32 s26, 7
    s_cselect_b32 s27, 7, 0
    s_sub_u32 s26, s26, s27
    s_add_u32 m0, s76, 8192
    s_mul_i32 s26, s26, 229376
    buffer_load_dwordx4 v254, s[68:71], s26 offen nt lds
    s_waitcnt vmcnt(4)
    s_add_u32 s26, s49, 2
    s_cmp_ge_u32 s26, 7
    s_cselect_b32 s27, 7, 0
    s_sub_u32 s26, s26, s27
    s_add_u32 m0, s76, 65536
    s_add_u32 s26, s26, 14
    s_mul_i32 s26, s26, 229376
    buffer_load_dwordx4 v254, s[68:71], s26 offen nt lds
    s_waitcnt vmcnt(4)
    s_add_u32 s26, s49, 3
    s_cmp_ge_u32 s26, 7
    s_cselect_b32 s27, 7, 0
    s_sub_u32 s26, s26, s27
    s_add_u32 m0, s76, 12288
    s_mul_i32 s26, s26, 229376
    buffer_load_dwordx4 v254, s[68:71], s26 offen nt lds
    s_waitcnt vmcnt(4)
    s_add_u32 s26, s49, 3
    s_cmp_ge_u32 s26, 7
    s_cselect_b32 s27, 7, 0
    s_sub_u32 s26, s26, s27
    s_add_u32 m0, s76, 69632
    s_add_u32 s26, s26, 14
    s_mul_i32 s26, s26, 229376
    buffer_load_dwordx4 v254, s[68:71], s26 offen nt lds
    s_waitcnt vmcnt(4)
    s_add_u32 s26, s49, 4
    s_cmp_ge_u32 s26, 7
    s_cselect_b32 s27, 7, 0
    s_sub_u32 s26, s26, s27
    s_add_u32 m0, s76, 16384
    s_mul_i32 s26, s26, 229376
    buffer_load_dwordx4 v254, s[68:71], s26 offen nt lds
    s_waitcnt vmcnt(4)
    s_add_u32 s26, s49, 4
    s_cmp_ge_u32 s26, 7
    s_cselect_b32 s27, 7, 0
    s_sub_u32 s26, s26, s27
    s_add_u32 m0, s76, 73728
    s_add_u32 s26, s26, 14
    s_mul_i32 s26, s26, 229376
    buffer_load_dwordx4 v254, s[68:71], s26 offen nt lds
    s_waitcnt vmcnt(4)
    s_add_u32 s26, s49, 5
    s_cmp_ge_u32 s26, 7
    s_cselect_b32 s27, 7, 0
    s_sub_u32 s26, s26, s27
    s_add_u32 m0, s76, 20480
    s_mul_i32 s26, s26, 229376
    buffer_load_dwordx4 v254, s[68:71], s26 offen nt lds
    s_waitcnt vmcnt(4)
    s_add_u32 s26, s49, 5
    s_cmp_ge_u32 s26, 7
    s_cselect_b32 s27, 7, 0
    s_sub_u32 s26, s26, s27
    s_add_u32 m0, s76, 77824
    s_add_u32 s26, s26, 14
    s_mul_i32 s26, s26, 229376
    buffer_load_dwordx4 v254, s[68:71], s26 offen nt lds
    s_waitcnt vmcnt(4)
    s_add_u32 s26, s49, 6
    s_cmp_ge_u32 s26, 7
    s_cselect_b32 s27, 7, 0
    s_sub_u32 s26, s26, s27
    s_add_u32 m0, s76, 24576
    s_mul_i32 s26, s26, 229376
    buffer_load_dwordx4 v254, s[68:71], s26 offen nt lds
    s_waitcnt vmcnt(4)
    s_add_u32 s26, s49, 6
    s_cmp_ge_u32 s26, 7
    s_cselect_b32 s27, 7, 0
    s_sub_u32 s26, s26, s27
    s_add_u32 m0, s76, 81920
    s_add_u32 s26, s26, 14
    s_mul_i32 s26, s26, 229376
    buffer_load_dwordx4 v254, s[68:71], s26 offen nt lds
L_p3:
    s_bfe_u32 s32, s37, 0x80000
    s_bfe_u32 s33, s37, 0x80008
    s_bfe_u32 s34, s37, 0x80010
    s_bfe_u32 s35, s37, 0x80018
    s_getreg_b32 s46, hwreg(HW_REG_XCC_ID, 0, 4)
    s_add_u32 s46, s46, s37
    s_mov_b32 s52, s16
    s_mov_b32 s53, s17
    s_mov_b32 s54, 0x70000
    s_mov_b32 s55, 0x20000
    s_mov_b32 s30, 131072
    s_load_dword s50, s[20:21], s13
    s_waitcnt vmcnt(4) lgkmcnt(0)
L_claimed:
    s_barrier
    buffer_load_dwordx4 v[16:19], v255, s[64:67], s4 offen sc1
    buffer_load_dwordx4 v[20:23], v255, s[64:67], s4 offen offset:512 sc1
    buffer_load_dwordx4 v[24:27], v255, s[64:67], s5 offen sc1
    ds_read_b64_tr_b16 v[112:113], v232 offset:0
    ds_read_b64_tr_b16 v[114:115], v232 offset:512
    ds_read_b64_tr_b16 v[116:117], v233 offset:0
    ds_read_b64_tr_b16 v[118:119], v233 offset:512
    ds_read_b64_tr_b16 v[120:121], v232 offset:2048
    ds_read_b64_tr_b16 v[122:123], v232 offset:2560
    ds_read_b64_tr_b16 v[124:125], v233 offset:2048
    ds_read_b64_tr_b16 v[126:127], v233 offset:2560
    ds_read_b64_tr_b16 v[128:129], v232 offset:4096
    ds_read_b64_tr_b16 v[130:131], v232 offset:4608
    ds_read_b64_tr_b16 v[132:133], v233 offset:4096
    ds_read_b64_tr_b16 v[134:135], v233 offset:4608
    ds_read_b64_tr_b16 v[136:137], v232 offset:6144
    ds_read_b64_tr_b16 v[138:139], v232 offset:6656
    ds_read_b64_tr_b16 v[140:141], v233 offset:6144
    ds_read_b64_tr_b16 v[142:143], v233 offset:6656
    ds_read_b64_tr_b16 v[144:145], v232 offset:8192
    ds_read_b64_tr_b16 v[146:147], v232 offset:8704
    ds_read_b64_tr_b16 v[148:149], v233 offset:8192
    ds_read_b64_tr_b16 v[150:151], v233 offset:8704
    ds_read_b64_tr_b16 v[152:153], v232 offset:10240
    ds_read_b64_tr_b16 v[154:155], v232 offset:10752
    ds_read_b64_tr_b16 v[156:157], v233 offset:10240
    ds_read_b64_tr_b16 v[158:159], v233 offset:10752
    ds_read_b64_tr_b16 v[160:161], v232 offset:12288
    ds_read_b64_tr_b16 v[162:163], v232 offset:12800
    ds_read_b64_tr_b16 v[164:165], v233 offset:12288
    ds_read_b64_tr_b16 v[166:167], v233 offset:12800
    ds_read_b64_tr_b16 v[168:169], v232 offset:14336
    ds_read_b64_tr_b16 v[170:171], v232 offset:14848
    ds_read_b64_tr_b16 v[172:173], v233 offset:14336
    ds_read_b64_tr_b16 v[174:175], v233 offset:14848
    ds_read_b64_tr_b16 v[176:177], v232 offset:16384
    ds_read_b64_tr_b16 v[178:179], v232 offset:16896
    ds_read_b64_tr_b16 v[180:181], v233 offset:16384
    ds_read_b64_tr_b16 v[182:183], v233 offset:16896
    ds_read_b64_tr_b16 v[184:185], v232 offset:18432
    ds_read_b64_tr_b16 v[186:187], v232 offset:18944
    ds_read_b64_tr_b16 v[188:189], v233 offset:18432
    ds_read_b64_tr_b16 v[190:191], v233 offset:18944
    buffer_load_dwordx4 v[28:31], v255, s[64:67], s5 offen offset:512 sc1
    buffer_load_dwordx4 v[32:35], v255, s[64:67], s8 offen sc1
    buffer_load_dwordx4 v[36:39], v255, s[64:67], s8 offen offset:512 sc1
    s_waitcnt vmcnt(6)
    s_barrier
    s_branch L_p3_run
L_hpoll:
    buffer_load_dword v4, v253, s[64:67], 0 offen sc1
    s_sleep 1
    s_waitcnt vmcnt(0)
    v_cmp_eq_u32 vcc, -1, v4
    s_cbranch_vccz L_hgo
    s_sub_u32 s30, s30, 1
    s_cmp_ge_i32 s30, 0
    s_cbranch_scc1 L_hpoll
L_hgo:
    buffer_load_dwordx4 v[16:19], v255, s[64:67], s4 offen sc1
    buffer_load_dwordx4 v[20:23], v255, s[64:67], s4 offen offset:512 sc1
    buffer_load_dwordx4 v[24:27], v255, s[64:67], s5 offen sc1
    buffer_load_dwordx4 v[28:31], v255, s[64:67], s5 offen offset:512 sc1
    buffer_load_dwordx4 v[32:35], v255, s[64:67], s8 offen sc1
    buffer_load_dwordx4 v[36:39], v255, s[64:67], s8 offen offset:512 sc1
    s_load_dword s50, s[20:21], s13 glc
    s_waitcnt lgkmcnt(0)
L_p3_run:
    s_waitcnt vmcnt(5)
    buffer_load_dwordx4 v[40:43], v255, s[64:67], s9 offen sc1
    s_waitcnt lgkmcnt(0)
    v_mfma_f32_32x32x16_bf16 v[80:95], v[112:115], v[16:19], 0
    v_max3_u32 v5, v16, v17, v18
    v_max_u32 v5, v5, v19
    ds_read_b64_tr_b16 v[192:193], v232 offset:20480
    ds_read_b64_tr_b16 v[194:195], v232 offset:20992
    v_mfma_f32_32x32x16_bf16 v[96:111], v[116:119], v[16:19], 0
    ds_read_b64_tr_b16 v[196:197], v233 offset:20480
    ds_read_b64_tr_b16 v[198:199], v233 offset:20992
    s_waitcnt vmcnt(5)
    buffer_load_dwordx4 v[44:47], v255, s[64:67], s9 offen offset:512 sc1
    v_mfma_f32_32x32x16_bf16 v[80:95], v[120:123], v[20:23], v[80:95]
    v_max3_u32 v5, v5, v20, v21
    v_max3_u32 v5, v5, v22, v23
    ds_read_b64_tr_b16 v[200:201], v232 offset:22528
    ds_read_b64_tr_b16 v[202:203], v232 offset:23040
    v_mfma_f32_32x32x16_bf16 v[96:111], v[124:127], v[20:23], v[96:111]
    ds_read_b64_tr_b16 v[204:205], v233 offset:22528
    ds_read_b64_tr_b16 v[206:207], v233 offset:23040
    v_cmp_eq_u32 vcc, -1, v5
    s_cbranch_vccnz L_p3_bad
    s_waitcnt vmcnt(5)
    buffer_load_dwordx4 v[48:51], v255, s[64:67], s10 offen sc1
    v_mfma_f32_32x32x16_bf16 v[80:95], v[128:131], v[24:27], v[80:95]
    v_max3_u32 v5, v5, v24, v25
    v_max3_u32 v5, v5, v26, v27
    ds_read_b64_tr_b16 v[208:209], v232 offset:24576
    ds_read_b64_tr_b16 v[210:211], v232 offset:25088
    v_mfma_f32_32x32x16_bf16 v[96:111], v[132:135], v[24:27], v[96:111]
    ds_read_b64_tr_b16 v[212:213], v233 offset:24576
    ds_read_b64_tr_b16 v[214:215], v233 offset:25088
    s_waitcnt vmcnt(5)
    buffer_load_dwordx4 v[52:55], v255, s[64:67], s10 offen offset:512 sc1
    v_mfma_f32_32x32x16_bf16 v[80:95], v[136:139], v[28:31], v[80:95]
    v_max3_u32 v5, v5, v28, v29
    v_max3_u32 v5, v5, v30, v31
    ds_read_b64_tr_b16 v[216:217], v232 offset:26624
    ds_read_b64_tr_b16 v[218:219], v232 offset:27136
    v_mfma_f32_32x32x16_bf16 v[96:111], v[140:143], v[28:31], v[96:111]
    ds_read_b64_tr_b16 v[220:221], v233 offset:26624
    ds_read_b64_tr_b16 v[222:223], v233 offset:27136
    s_waitcnt vmcnt(5)
    buffer_load_dwordx4 v[56:59], v255, s[64:67], s11 offen sc1
    v_mfma_f32_32x32x16_bf16 v[80:95], v[144:147], v[32:35], v[80:95]
    v_max3_u32 v5, v5, v32, v33
    v_max3_u32 v5, v5, v34, v35
    v_mfma_f32_32x32x16_bf16 v[96:111], v[148:151], v[32:35], v[96:111]
    v_cmp_eq_u32 vcc, -1, v5
    s_cbranch_vccnz L_p3_bad
    s_waitcnt vmcnt(5)
    buffer_load_dwordx4 v[60:63], v255, s[64:67], s11 offen offset:512 sc1
    v_mfma_f32_32x32x16_bf16 v[80:95], v[152:155], v[36:39], v[80:95]
    v_max3_u32 v5, v5, v36, v37
    v_max3_u32 v5, v5, v38, v39
    v_mfma_f32_32x32x16_bf16 v[96:111], v[156:159], v[36:39], v[96:111]
    s_waitcnt vmcnt(5)
    buffer_load_dwordx4 v[64:67], v255, s[64:67], s12 offen sc1
    v_mfma_f32_32x32x16_bf16 v[80:95], v[160:163], v[40:43], v[80:95]
    v_max3_u32 v5, v5, v40, v41
    v_max3_u32 v5, v5, v42, v43
    v_mfma_f32_32x32x16_bf16 v[96:111], v[164:167], v[40:43], v[96:111]
    s_waitcnt vmcnt(5)
    buffer_load_dwordx4 v[68:71], v255, s[64:67], s12 offen offset:512 sc1
    v_mfma_f32_32x32x16_bf16 v[80:95], v[168:171], v[44:47], v[80:95]
    v_max3_u32 v5, v5, v44, v45
    v_max3_u32 v5, v5, v46, v47
    v_mfma_f32_32x32x16_bf16 v[96:111], v[172:175], v[44:47], v[96:111]
    s_waitcnt vmcnt(5)
    v_mfma_f32_32x32x16_bf16 v[80:95], v[176:179], v[48:51], v[80:95]
    v_max3_u32 v5, v5, v48, v49
    v_max3_u32 v5, v5, v50, v51
    v_mfma_f32_32x32x16_bf16 v[96:111], v[180:183], v[48:51], v[96:111]
    v_cmp_eq_u32 vcc, -1, v5
    s_cbranch_vccnz L_p3_bad
    s_waitcnt vmcnt(4)
    v_mfma_f32_32x32x16_bf16 v[80:95], v[184:187], v[52:55], v[80:95]
    v_max3_u32 v5, v5, v52, v53
    v_max3_u32 v5, v5, v54, v55
    v_mfma_f32_32x32x16_bf16 v[96:111], v[188:191], v[52:55], v[96:111]
    s_waitcnt vmcnt(3)
    s_waitcnt lgkmcnt(0)
    v_mfma_f32_32x32x16_bf16 v[80:95], v[192:195], v[56:59], v[80:95]
    v_max3_u32 v5, v5, v56, v57
    v_max3_u32 v5, v5, v58, v59
    v_mfma_f32_32x32x16_bf16 v[96:111], v[196:199], v[56:59], v[96:111]
    s_waitcnt vmcnt(2)
    v_mfma_f32_32x32x16_bf16 v[80:95], v[200:203], v[60:63], v[80:95]
    v_max3_u32 v5, v5, v60, v61
    v_max3_u32 v5, v5, v62, v63
    v_mfma_f32_32x32x16_bf16 v[96:111], v[204:207], v[60:63], v[96:111]
    s_waitcnt vmcnt(1)
    v_mfma_f32_32x32x16_bf16 v[80:95], v[208:211], v[64:67], v[80:95]
    v_max3_u32 v5, v5, v64, v65
    v_max3_u32 v5, v5, v66, v67
    v_mfma_f32_32x32x16_bf16 v[96:111], v[212:215], v[64:67], v[96:111]
    s_waitcnt vmcnt(0)
    v_mfma_f32_32x32x16_bf16 v[80:95], v[216:219], v[68:71], v[80:95]
    v_max3_u32 v5, v5, v68, v69
    v_max3_u32 v5, v5, v70, v71
    v_mfma_f32_32x32x16_bf16 v[96:111], v[220:223], v[68:71], v[96:111]
    v_cmp_eq_u32 vcc, -1, v5
    s_cbranch_vccz L_p3_ok
L_p3_bad:
    s_sub_u32 s30, s30, 1
    s_cmp_lt_i32 s30, 0
    s_cbranch_scc1 L_p3_ok
    s_branch L_hpoll
L_p3_ok:
    s_nop 7
    ds_write_b128 v235, v[88:91] offset:0
    ds_write_b128 v235, v[92:95] offset:1024
    s_nop 1
    ds_write_b128 v236, v[96:99] offset:0
    ds_write_b128 v236, v[100:103] offset:1024
    ds_write_b128 v237, v[104:107] offset:0
    ds_write_b128 v237, v[108:111] offset:1024
    s_mov_b32 s30, 131072
    s_waitcnt lgkmcnt(0)
    s_barrier
    ds_read_b128 v[16:19], v234 offset:0
    ds_read_b128 v[20:23], v234 offset:1024
    ds_read_b128 v[24:27], v234 offset:2048
    ds_read_b128 v[28:31], v234 offset:3072
    ds_read_b128 v[32:35], v234 offset:4096
    ds_read_b128 v[36:39], v234 offset:5120
    s_cmp_eq_u32 s75, 0
    s_cbranch_scc1 L_p4_own
    s_waitcnt lgkmcnt(4)
    v_pk_add_f32 v[80:81], v[80:81], v[16:17]
    v_pk_add_f32 v[82:83], v[82:83], v[18:19]
    v_pk_add_f32 v[84:85], v[84:85], v[20:21]
    v_pk_add_f32 v[86:87], v[86:87], v[22:23]
    s_waitcnt lgkmcnt(2)
    v_pk_add_f32 v[80:81], v[80:81], v[24:25]
    v_pk_add_f32 v[82:83], v[82:83], v[26:27]
    v_pk_add_f32 v[84:85], v[84:85], v[28:29]
    v_pk_add_f32 v[86:87], v[86:87], v[30:31]
    s_waitcnt lgkmcnt(0)
    v_pk_add_f32 v[80:81], v[80:81], v[32:33]
    v_pk_add_f32 v[82:83], v[82:83], v[34:35]
    v_pk_add_f32 v[84:85], v[84:85], v[36:37]
    v_pk_add_f32 v[86:87], v[86:87], v[38:39]
    v_and_or_b32 v80, v80, v245, s32
    v_and_or_b32 v81, v81, v245, s33
    v_and_or_b32 v82, v82, v245, s34
    v_and_or_b32 v83, v83, v245, s35
    v_and_or_b32 v84, v84, v245, s32
    v_and_or_b32 v85, v85, v245, s33
    v_and_or_b32 v86, v86, v245, s34
    v_and_or_b32 v87, v87, v245, s35
    s_cmp_eq_u32 s50, s46
    s_cbranch_scc1 L_send_loc
    buffer_store_dwordx4 v[80:83], v252, s[64:67], s72 offen offset:0 sc1
    buffer_store_dwordx4 v[84:87], v252, s[64:67], s72 offen offset:1024 sc1
    s_branch L_fin
L_send_loc:
    buffer_store_dwordx4 v[80:83], v252, s[64:67], s72 offen offset:0
    buffer_store_dwordx4 v[84:87], v252, s[64:67], s72 offen offset:1024
    s_branch L_fin
L_p4_own:
    s_waitcnt lgkmcnt(4)
    v_pk_add_f32 v[80:81], v[80:81], v[16:17]
    v_pk_add_f32 v[82:83], v[82:83], v[18:19]
    v_pk_add_f32 v[84:85], v[84:85], v[20:21]
    v_pk_add_f32 v[86:87], v[86:87], v[22:23]
    s_waitcnt lgkmcnt(2)
    v_pk_add_f32 v[80:81], v[80:81], v[24:25]
    v_pk_add_f32 v[82:83], v[82:83], v[26:27]
    v_pk_add_f32 v[84:85], v[84:85], v[28:29]
    v_pk_add_f32 v[86:87], v[86:87], v[30:31]
    s_waitcnt lgkmcnt(0)
    v_pk_add_f32 v[80:81], v[80:81], v[32:33]
    v_pk_add_f32 v[82:83], v[82:83], v[34:35]
    v_pk_add_f32 v[84:85], v[84:85], v[36:37]
    v_pk_add_f32 v[86:87], v[86:87], v[38:39]
L_p4_ld:
    buffer_load_dwordx4 v[40:43], v252, s[64:67], 0 offen offset:0 sc1
    buffer_load_dwordx4 v[44:47], v252, s[64:67], 0 offen offset:1024 sc1
    buffer_load_dwordx4 v[48:51], v252, s[64:67], 0 offen offset:2048 sc1
    buffer_load_dwordx4 v[52:55], v252, s[64:67], 0 offen offset:3072 sc1
    buffer_load_dwordx4 v[56:59], v252, s[64:67], s74 offen offset:0 sc1
    buffer_load_dwordx4 v[60:63], v252, s[64:67], s74 offen offset:1024 sc1
    s_waitcnt vmcnt(5)
    v_xor_b32 v40, s32, v40
    v_xor_b32 v41, s33, v41
    v_xor_b32 v42, s34, v42
    v_xor_b32 v43, s35, v43
    v_or3_b32 v5, v40, v41, v42
    v_or_b32 v5, v5, v43
    s_waitcnt vmcnt(4)
    v_xor_b32 v44, s32, v44
    v_xor_b32 v45, s33, v45
    v_xor_b32 v46, s34, v46
    v_xor_b32 v47, s35, v47
    v_or3_b32 v5, v5, v44, v45
    v_or3_b32 v5, v5, v46, v47
    s_waitcnt vmcnt(3)
    v_xor_b32 v48, s32, v48
    v_xor_b32 v49, s33, v49
    v_xor_b32 v50, s34, v50
    v_xor_b32 v51, s35, v51
    v_or3_b32 v5, v5, v48, v49
    v_or3_b32 v5, v5, v50, v51
    s_waitcnt vmcnt(2)
    v_xor_b32 v52, s32, v52
    v_xor_b32 v53, s33, v53
    v_xor_b32 v54, s34, v54
    v_xor_b32 v55, s35, v55
    v_or3_b32 v5, v5, v52, v53
    v_or3_b32 v5, v5, v54, v55
    s_waitcnt vmcnt(1)
    v_xor_b32 v56, s32, v56
    v_xor_b32 v57, s33, v57
    v_xor_b32 v58, s34, v58
    v_xor_b32 v59, s35, v59
    v_or3_b32 v5, v5, v56, v57
    v_or3_b32 v5, v5, v58, v59
    s_waitcnt vmcnt(0)
    v_xor_b32 v60, s32, v60
    v_xor_b32 v61, s33, v61
    v_xor_b32 v62, s34, v62
    v_xor_b32 v63, s35, v63
    v_or3_b32 v5, v5, v60, v61
    v_or3_b32 v5, v5, v62, v63
    v_and_b32 v5, 0xff, v5
    v_cmp_ne_u32 vcc, 0, v5
    s_cbranch_vccz L_p4_ok
    s_sub_u32 s30, s30, 1
    s_cmp_lt_i32 s30, 0
    s_cbranch_scc1 L_p4_ok
    s_branch L_p4_ld
L_p4_ok:
    v_pk_add_f32 v[48:49], v[48:49], v[56:57]
    v_pk_add_f32 v[50:51], v[50:51], v[58:59]
    v_pk_add_f32 v[52:53], v[52:53], v[60:61]
    v_pk_add_f32 v[54:55], v[54:55], v[62:63]
    v_pk_add_f32 v[80:81], v[80:81], v[40:41]
    v_pk_add_f32 v[82:83], v[82:83], v[42:43]
    v_pk_add_f32 v[84:85], v[84:85], v[44:45]
    v_pk_add_f32 v[86:87], v[86:87], v[46:47]
    v_pk_add_f32 v[80:81], v[80:81], v[48:49]
    v_pk_add_f32 v[82:83], v[82:83], v[50:51]
    v_pk_add_f32 v[84:85], v[84:85], v[52:53]
    v_pk_add_f32 v[86:87], v[86:87], v[54:55]
    v_cvt_pk_bf16_f32 v8, v80, v81
    v_cvt_pk_bf16_f32 v9, v82, v83
    v_cvt_pk_bf16_f32 v10, v84, v85
    v_cvt_pk_bf16_f32 v11, v86, v87
    s_nop 1
    v_permlane32_swap_b32 v8, v10
    v_permlane32_swap_b32 v9, v11
    buffer_store_dwordx4 v[8:11], v251, s[52:55], 0 offen
L_fin:
L_end:
    s_endpgm
L_codeend:
.section .rodata,"a"
.p2align 6
.amdhsa_kernel standalone__weight_only_int_quip__sampling_kernel
    .amdhsa_next_free_vgpr 256
    .amdhsa_next_free_sgpr 102
    .amdhsa_accum_offset 256
    .amdhsa_group_segment_fixed_size 0
    .amdhsa_kernarg_size 72
    .amdhsa_user_sgpr_count 2
    .amdhsa_user_sgpr_kernarg_segment_ptr 1
    .amdhsa_system_sgpr_workgroup_id_x 1
    .amdhsa_float_denorm_mode_32 3
.end_amdhsa_kernel
```
